```python
import torch

def _softmax(x, axis=-1):
    return torch.softmax(x, dim=axis)

def _gelu(x):
    return torch.nn.functional.gelu(x, approximate='tanh')

def _silu(x):
    return torch.nn.functional.silu(x)

def _sigmoid(x):
    return torch.sigmoid(x)

def _layernorm(x, axis=-1, eps=1e-05):
    m = x.mean(dim=axis, keepdim=True)
    v = x.var(dim=axis, keepdim=True, unbiased=False)
    return (x - m) / torch.sqrt(v + eps)

def _scatter_add(tgt, idx, src, axis=0):
    return tgt.clone().index_add_(axis, idx, src)

def _segment_sum(src, seg, n):
    out = torch.zeros((n,) + src.shape[1:], dtype=src.dtype)
    return out.index_add_(0, seg, src)

def _pad(x, pw):
    flat = tuple((v for pair in reversed(pw) for v in pair))
    return torch.nn.functional.pad(x, flat)
kernel_name = 'adaLN_cond__sliding_local_dilated__glu_gated_swiglu__prompt'

def setup_inputs():

    _w = lambda a: (lambda t: t.to(torch.bfloat16) if t.is_floating_point() else t)(torch.as_tensor(a))

    def _A_setup():
        B, S, D = (1, 2048, 512)
        return {'x': _w((lambda *s: torch.randn(*s, dtype=torch.bfloat16) * 0.05)(B, S, D)), 'wqkv': _w((lambda *s: torch.randn(*s, dtype=torch.bfloat16) * 0.1)(D, 3 * D)), 'wo': _w((lambda *s: torch.randn(*s, dtype=torch.bfloat16) * 0.1)(D, D))}
    _A_in = _A_setup()

    def _B_setup():
        B, S, D, F = (1, 2048, 512, 1376)
        return {'x': _w((lambda *s: torch.randn(*s, dtype=torch.bfloat16) * 0.05)(B, S, D)), 'w1': _w((lambda *s: torch.randn(*s, dtype=torch.bfloat16) * 1.6)(D, F) * (2.0 / D) ** 0.5), 'w3': _w((lambda *s: torch.randn(*s, dtype=torch.bfloat16) * 1.6)(D, F) * (2.0 / D) ** 0.5), 'w2': _w((lambda *s: torch.randn(*s, dtype=torch.bfloat16) * 1.6)(F, D) * (2.0 / F) ** 0.5)}
    _B_in = _B_setup()
    return {'A_x': _A_in['x'], 'A_wqkv': _A_in['wqkv'], 'A_wo': _A_in['wo'], 'B_x': _B_in['x'], 'B_w1': _B_in['w1'], 'B_w3': _B_in['w3'], 'B_w2': _B_in['w2'], 'c': _w((lambda *s: torch.randn(*s, dtype=torch.bfloat16) * 0.2)(1, 512) * 8.0), 'w_mod': _w((lambda *s: torch.randn(*s, dtype=torch.bfloat16) * 0.2)(512, 6 * 512) * 512 ** (-0.5) * 8.0)}

def reference(A_x, A_wqkv, A_wo, B_x, B_w1, B_w3, B_w2, c, w_mod):

    def _A_ref(x, wqkv, wo):
        B, S, D = x.shape
        H = 32
        Dh = D // H
        W, dil = (8, 2)
        qkv = (lambda x, *d: x.permute(*d))((x @ wqkv).reshape(B, S, 3, H, Dh), 2, 0, 3, 1, 4)
        q, k, v = (qkv[0], qkv[1], qkv[2])
        scale = Dh ** (-0.5)
        pos = torch.arange(S)
        off = torch.arange(W) * dil
        idx = pos[:, None] - off[None, :]
        mask = idx >= 0
        idx_c = torch.where(mask, idx, 0).reshape(-1)
        kg = k[:, :, idx_c, :].reshape(B, H, S, W, Dh)
        vg = v[:, :, idx_c, :].reshape(B, H, S, W, Dh)
        logits = torch.einsum('bhsd,bhswd->bhsw', q, kg) * scale
        logits = torch.where(mask[None, None, :, :], logits, -1000000000.0)
        attn = _softmax(logits, axis=-1)
        o = torch.einsum('bhsw,bhswd->bhsd', attn, vg)
        return (lambda x, *d: x.permute(*d))(o, 0, 2, 1, 3).reshape(B, S, D) @ wo

    def _B_ref(x, w1, w3, w2):
        gate = torch.einsum('bsd,df->bsf', x, w1)
        up = torch.einsum('bsd,df->bsf', x, w3)
        h = _silu(gate) * up
        out = torch.einsum('bsf,fd->bsd', h, w2)
        return out
    x = A_x
    mod = (_silu(c) @ w_mod).reshape(c.shape[0], 6, 1, -1)
    sa, ca, ga, sb, cb, gb = (mod[:, 0].clone(), mod[:, 1].clone(), mod[:, 2].clone(), mod[:, 3].clone(), mod[:, 4].clone(), mod[:, 5].clone())
    h = _layernorm(x, axis=-1) * (1 + ca) + sa
    x = x + ga * _A_ref(h, A_wqkv, A_wo)
    h = _layernorm(x, axis=-1) * (1 + cb) + sb
    x = x + gb * _B_ref(h, B_w1, B_w3, B_w2)
    return x
```

```asm
; @launch kernel=k0_kernel grid=(256,1,1) block=(256,1,1) lds=32768
; @launch kernel=k1_kernel grid=(256,1,1) block=(256,1,1) lds=163840
.amdgcn_target "amdgcn-amd-amdhsa--gfx950"
.text
.globl k0_kernel
.p2align 8
.type k0_kernel,@function
k0_kernel:
    s_cmp_lt_u32 s2, 256
    s_nop 1
    s_cbranch_scc1 L_go_k0_kernel
    s_endpgm
    s_nop 1
L_go_k0_kernel:
    s_load_dwordx16 s[64:79], s[0:1], 0
    s_load_dwordx8 s[80:87], s[0:1], 64
    v_and_b32 v1, 63, v0
    v_and_b32 v2, 15, v0
    v_bfe_u32 v3, v0, 4, 2
    v_lshrrev_b32 v4, 6, v0
    s_nop 0
    v_readfirstlane_b32 s3, v4
    v_lshlrev_b32 v4, 4, v1
    s_bfe_u32 s4, s2, 0x20001
    s_lshl_b32 s4, s4, 2
    s_lshr_b32 s5, s2, 6
    s_or_b32 s4, s4, s5
    s_and_b32 s5, s2, 1
    s_lshl_b32 s5, s5, 3
    s_bfe_u32 s6, s2, 0x30003
    s_or_b32 s5, s5, s6
    s_waitcnt lgkmcnt(0)
    s_mov_b32 s8, s64
    s_and_b32 s9, s65, 0xffff
    s_mov_b32 s10, 0x200000
    s_mov_b32 s11, 0x20000
    s_mov_b32 s12, s66
    s_and_b32 s13, s67, 0xffff
    s_mov_b32 s14, 0x180000
    s_mov_b32 s15, 0x20000
    s_mov_b32 s16, s68
    s_and_b32 s17, s69, 0xffff
    s_mov_b32 s18, 0x80000
    s_mov_b32 s19, 0x20000
    s_mov_b32 s20, s72
    s_and_b32 s21, s73, 0xffff
    s_mov_b32 s22, 0x158000
    s_mov_b32 s23, 0x20000
    s_mov_b32 s24, s74
    s_and_b32 s25, s75, 0xffff
    s_mov_b32 s26, 0x158000
    s_mov_b32 s27, 0x20000
    s_mov_b32 s28, s76
    s_and_b32 s29, s77, 0xffff
    s_mov_b32 s30, 0x158000
    s_mov_b32 s31, 0x20000
    s_mov_b32 s32, s78
    s_and_b32 s33, s79, 0xffff
    s_mov_b32 s34, 0x400
    s_mov_b32 s35, 0x20000
    s_mov_b32 s36, s80
    s_and_b32 s37, s81, 0xffff
    s_mov_b32 s38, 0x300000
    s_mov_b32 s39, 0x20000
    s_mov_b32 s40, s82
    s_and_b32 s41, s83, 0xffff
    s_mov_b32 s42, 0x200000
    s_mov_b32 s43, 0x20000
    s_mov_b32 s48, s86
    s_and_b32 s49, s87, 0xffff
    s_mov_b32 s50, 0x10000000
    s_mov_b32 s51, 0x20000
    v_lshrrev_b32 v7, 2, v1
    v_and_b32 v8, 3, v1
    s_lshl_b32 s68, s4, 10
    s_cmp_ge_u32 s3, 2
    s_nop 2
    s_cbranch_scc1 W23_1
    v_and_b32 v11, 7, v1
    v_lshrrev_b32 v12, 3, v1
    v_lshlrev_b32 v13, 10, v12
    v_lshl_add_u32 v13, v11, 4, v13
    v_lshlrev_b32 v14, 10, v11
    v_lshl_add_u32 v14, v12, 4, v14
    s_lshl_b32 s6, s4, 7
    s_lshl_b32 s7, s5, 3
    s_add_u32 s6, s6, s7
    s_lshl_b32 s54, s6, 10
    s_lshl_b32 s7, s3, 9
    s_add_u32 s55, s54, s7
    buffer_load_dwordx4 v[64:67], v13, s[8:11], s54 offen offset:0
    buffer_load_dwordx4 v[68:71], v13, s[8:11], s54 offen offset:128
    buffer_load_dwordx4 v[72:75], v13, s[8:11], s54 offen offset:256
    buffer_load_dwordx4 v[76:79], v13, s[8:11], s54 offen offset:384
    buffer_load_dwordx4 v[80:83], v13, s[8:11], s54 offen offset:512
    buffer_load_dwordx4 v[84:87], v13, s[8:11], s54 offen offset:640
    buffer_load_dwordx4 v[88:91], v13, s[8:11], s54 offen offset:768
    buffer_load_dwordx4 v[92:95], v13, s[8:11], s54 offen offset:896
    buffer_load_dwordx4 v[96:99], v14, s[8:11], s55 offen offset:0
    buffer_load_dwordx4 v[100:103], v14, s[8:11], s55 offen offset:128
    buffer_load_dwordx4 v[104:107], v14, s[8:11], s55 offen offset:256
    buffer_load_dwordx4 v[108:111], v14, s[8:11], s55 offen offset:384
    v_lshlrev_b32 v16, 7, v1
    v_mov_b32 v19, 0
    s_lshl_b32 s6, s3, 4
    s_or_b32 s6, s6, s5
    s_cmp_eq_u32 s6, 0
    s_cselect_b32 s58, s68, 0x7f000000
    s_mov_b64 exec, 0xff
    buffer_store_dword v19, v16, s[48:51], s58 offen
    s_mov_b64 exec, 1
    buffer_load_dword v60, v4, s[32:35], 0 offen
    buffer_load_dword v61, v4, s[32:35], 0 offen
    buffer_load_dword v62, v4, s[32:35], 0 offen
    s_mov_b64 exec, -1
    s_nop 1
    s_branch J_2
    s_nop 1
W23_1:
    s_movk_i32 s6, 6144
    v_mul_lo_u32 v9, v7, s6
    v_lshl_add_u32 v9, v8, 4, v9
    s_and_b32 s63, s2, 3
    s_lshr_b32 s53, s2, 2
    s_lshl_b32 s53, s53, 1
    s_and_b32 s7, s3, 1
    s_add_u32 s53, s53, s7
    v_lshlrev_b32 v10, 1, v7
    s_lshl_b32 s6, s63, 8
    buffer_load_ushort v16, v10, s[32:35], s6 offen offset:0
    buffer_load_ushort v17, v10, s[32:35], s6 offen offset:32
    buffer_load_ushort v18, v10, s[32:35], s6 offen offset:64
    buffer_load_ushort v19, v10, s[32:35], s6 offen offset:96
    buffer_load_ushort v20, v10, s[32:35], s6 offen offset:128
    buffer_load_ushort v21, v10, s[32:35], s6 offen offset:160
    buffer_load_ushort v22, v10, s[32:35], s6 offen offset:192
    buffer_load_ushort v23, v10, s[32:35], s6 offen offset:224
    s_mul_i32 s58, s63, 786432
    s_lshl_b32 s59, s53, 6
    s_add_u32 s58, s58, s59
    s_cmp_ge_u32 s2, 192
    s_cselect_b32 s58, 0x7f000000, s58
    s_add_u32 s59, s58, 0
    buffer_load_dwordx4 v[64:67], v9, s[36:39], s59 offen
    s_add_u32 s59, s58, 98304
    buffer_load_dwordx4 v[68:71], v9, s[36:39], s59 offen
    s_add_u32 s59, s58, 196608
    buffer_load_dwordx4 v[72:75], v9, s[36:39], s59 offen
    s_add_u32 s59, s58, 294912
    buffer_load_dwordx4 v[76:79], v9, s[36:39], s59 offen
    s_add_u32 s59, s58, 393216
    buffer_load_dwordx4 v[80:83], v9, s[36:39], s59 offen
    s_add_u32 s59, s58, 491520
    buffer_load_dwordx4 v[84:87], v9, s[36:39], s59 offen
    s_add_u32 s59, s58, 589824
    buffer_load_dwordx4 v[88:91], v9, s[36:39], s59 offen
    s_add_u32 s59, s58, 688128
    buffer_load_dwordx4 v[92:95], v9, s[36:39], s59 offen
    s_nop 0
J_2:
    s_lshl_b32 s52, s2, 2
    s_add_u32 s52, s52, s3
    s_lshl_b32 s70, s3, 13
    s_cmp_ge_u32 s52, 768
    s_nop 1
    s_cbranch_scc1 TA_3
    s_mov_b64 s[56:57], s[12:13]
    s_mov_b32 s58, 0x180000
    s_mul_i32 s6, s52, 1366
    s_lshr_b32 s6, s6, 16
    s_mul_i32 s7, s6, 48
    s_sub_u32 s7, s52, s7
    s_mul_i32 s54, s6, 98304
    s_lshl_b32 s60, s7, 6
    s_add_u32 s54, s54, s60
    s_movk_i32 s55, 3072
    s_and_b32 s60, s7, 15
    s_mul_i32 s60, s60, 98304
    s_lshr_b32 s61, s7, 4
    s_lshl_b32 s61, s61, 15
    s_add_u32 s60, s60, s61
    s_lshl_b32 s6, s6, 10
    s_add_u32 s60, s60, s6
    s_add_u32 s72, s60, 22020096
    s_add_u32 s73, s72, 16384
    s_mov_b32 s80, 1
    s_nop 1
    s_branch TB_4
    s_nop 1
TA_3:
    s_mov_b64 s[56:57], s[16:17]
    s_mov_b32 s58, 0x80000
    s_sub_u32 s7, s52, 768
    s_lshr_b32 s6, s7, 4
    s_and_b32 s7, s7, 15
    s_lshl_b32 s54, s6, 15
    s_lshl_b32 s60, s7, 6
    s_add_u32 s54, s54, s60
    s_movk_i32 s55, 1024
    s_lshl_b32 s60, s7, 15
    s_lshl_b32 s6, s6, 10
    s_add_u32 s60, s60, s6
    s_add_u32 s72, s60, 24117248
    s_add_u32 s73, s72, 16384
    s_mov_b32 s80, 0
    s_nop 1
TB_4:
    s_mov_b32 s59, 0x20000
    v_mul_lo_u32 v44, v7, s55
    v_lshl_add_u32 v44, v8, 4, v44
    s_add_u32 m0, s70, 0
    s_nop 0
    buffer_load_dwordx4 v44, s[56:59], s54 offen lds
    s_lshl_b32 s55, s55, 4
    s_add_u32 s54, s54, s55
    s_add_u32 m0, s70, 1024
    s_nop 0
    buffer_load_dwordx4 v44, s[56:59], s54 offen lds
    s_cmp_ge_u32 s52, 688
    s_nop 1
    s_cbranch_scc1 TA_5
    s_mov_b64 s[56:57], s[20:21]
    s_mov_b32 s58, 0x158000
    s_mul_i32 s6, s52, 1525
    s_lshr_b32 s6, s6, 16
    s_mul_i32 s7, s6, 43
    s_sub_u32 s7, s52, s7
    s_mul_i32 s54, s6, 88064
    s_lshl_b32 s60, s7, 6
    s_add_u32 s54, s54, s60
    s_movk_i32 s55, 2752
    s_lshl_b32 s60, s7, 16
    s_lshl_b32 s6, s6, 10
    s_add_u32 s60, s60, s6
    s_add_u32 s74, s60, 17825792
    s_add_u32 s75, s74, 16384
    s_nop 1
    s_branch TB_6
    s_nop 1
TA_5:
    s_add_u32 s7, s52, -688
    s_mov_b64 s[56:57], s[28:29]
    s_mov_b32 s58, 0x158000
    s_and_b32 s6, s7, 15
    s_lshr_b32 s7, s7, 4
    s_lshl_b32 s54, s7, 15
    s_lshl_b32 s60, s6, 6
    s_add_u32 s54, s54, s60
    s_movk_i32 s55, 1024
    s_mul_i32 s60, s6, 88064
    s_lshl_b32 s61, s7, 10
    s_add_u32 s60, s60, s61
    s_add_u32 s74, s60, 25165824
    s_add_u32 s75, s74, 44032
    s_cmp_ge_u32 s7, 43
    s_cselect_b32 s74, 0x7f000000, s74
    s_cselect_b32 s75, 0x7f000000, s75
    s_nop 1
TB_6:
    s_mov_b32 s81, 0
    s_mov_b32 s59, 0x20000
    v_mul_lo_u32 v44, v7, s55
    v_lshl_add_u32 v44, v8, 4, v44
    s_add_u32 m0, s70, 2048
    s_nop 0
    buffer_load_dwordx4 v44, s[56:59], s54 offen lds
    s_lshl_b32 s55, s55, 4
    s_add_u32 s54, s54, s55
    s_add_u32 m0, s70, 3072
    s_nop 0
    buffer_load_dwordx4 v44, s[56:59], s54 offen lds
    s_cmp_ge_u32 s52, 688
    s_nop 1
    s_cbranch_scc1 TA_7
    s_mov_b64 s[56:57], s[24:25]
    s_mov_b32 s58, 0x158000
    s_mul_i32 s6, s52, 1525
    s_lshr_b32 s6, s6, 16
    s_mul_i32 s7, s6, 43
    s_sub_u32 s7, s52, s7
    s_mul_i32 s54, s6, 88064
    s_lshl_b32 s60, s7, 6
    s_add_u32 s54, s54, s60
    s_movk_i32 s55, 2752
    s_lshl_b32 s60, s7, 16
    s_lshl_b32 s6, s6, 10
    s_add_u32 s60, s60, s6
    s_add_u32 s76, s60, 17858560
    s_add_u32 s77, s76, 16384
    s_nop 1
    s_branch TB_8
    s_nop 1
TA_7:
    s_add_u32 s7, s52, -352
    s_mov_b64 s[56:57], s[28:29]
    s_mov_b32 s58, 0x158000
    s_and_b32 s6, s7, 15
    s_lshr_b32 s7, s7, 4
    s_lshl_b32 s54, s7, 15
    s_lshl_b32 s60, s6, 6
    s_add_u32 s54, s54, s60
    s_movk_i32 s55, 1024
    s_mul_i32 s60, s6, 88064
    s_lshl_b32 s61, s7, 10
    s_add_u32 s60, s60, s61
    s_add_u32 s76, s60, 25165824
    s_add_u32 s77, s76, 44032
    s_cmp_ge_u32 s7, 43
    s_cselect_b32 s76, 0x7f000000, s76
    s_cselect_b32 s77, 0x7f000000, s77
    s_nop 1
TB_8:
    s_mov_b32 s82, 0
    s_mov_b32 s59, 0x20000
    v_mul_lo_u32 v44, v7, s55
    v_lshl_add_u32 v44, v8, 4, v44
    s_add_u32 m0, s70, 4096
    s_nop 0
    buffer_load_dwordx4 v44, s[56:59], s54 offen lds
    s_lshl_b32 s55, s55, 4
    s_add_u32 s54, s54, s55
    s_add_u32 m0, s70, 5120
    s_nop 0
    buffer_load_dwordx4 v44, s[56:59], s54 offen lds
    s_add_u32 s7, s52, 672
    s_mov_b64 s[56:57], s[28:29]
    s_mov_b32 s58, 0x158000
    s_and_b32 s6, s7, 15
    s_lshr_b32 s7, s7, 4
    s_lshl_b32 s54, s7, 15
    s_lshl_b32 s60, s6, 6
    s_add_u32 s54, s54, s60
    s_movk_i32 s55, 1024
    s_mul_i32 s60, s6, 88064
    s_lshl_b32 s61, s7, 10
    s_add_u32 s60, s60, s61
    s_add_u32 s78, s60, 25165824
    s_add_u32 s79, s78, 44032
    s_cmp_ge_u32 s7, 43
    s_cselect_b32 s78, 0x7f000000, s78
    s_cselect_b32 s79, 0x7f000000, s79
    s_nop 1
TB_10:
    s_mov_b32 s83, 0
    s_mov_b32 s59, 0x20000
    v_mul_lo_u32 v44, v7, s55
    v_lshl_add_u32 v44, v8, 4, v44
    s_add_u32 m0, s70, 6144
    s_nop 0
    buffer_load_dwordx4 v44, s[56:59], s54 offen lds
    s_lshl_b32 s55, s55, 4
    s_add_u32 s54, s54, s55
    s_add_u32 m0, s70, 7168
    s_nop 0
    buffer_load_dwordx4 v44, s[56:59], s54 offen lds
    s_cmp_ge_u32 s3, 2
    s_nop 1
    s_cbranch_scc1 W23_11
    v_lshlrev_b32 v48, 8, v12
    v_lshl_add_u32 v48, v11, 4, v48
    v_add_u32 v49, 4096, v48
    s_lshl_b32 s6, s4, 3
    s_lshr_b32 s7, s5, 1
    s_add_u32 s6, s6, s7
    s_lshl_b32 s6, s6, 14
    s_and_b32 s7, s5, 1
    s_lshl_b32 s7, s7, 7
    s_add_u32 s6, s6, s7
    s_lshl_b32 s59, s3, 13
    s_add_u32 s6, s6, s59
    s_add_u32 s60, s6, 1048576
    v_lshlrev_b32 v50, 5, v11
    v_mov_b32 v20, 0
    v_mov_b32 v21, 0
    v_mov_b32 v22, 0x3f803f80
    v_mov_b32 v23, 0
    v_mov_b32 v24, 0
    s_waitcnt vmcnt(23)
    v_dot2_f32_bf16 v20, v64, v22, v20
    v_dot2_f32_bf16 v21, v64, v64, v21
    v_dot2_f32_bf16 v23, v65, v22, v23
    v_dot2_f32_bf16 v24, v65, v65, v24
    v_dot2_f32_bf16 v20, v66, v22, v20
    v_dot2_f32_bf16 v21, v66, v66, v21
    v_dot2_f32_bf16 v23, v67, v22, v23
    v_dot2_f32_bf16 v24, v67, v67, v24
    s_waitcnt vmcnt(22)
    v_dot2_f32_bf16 v20, v68, v22, v20
    v_dot2_f32_bf16 v21, v68, v68, v21
    v_dot2_f32_bf16 v23, v69, v22, v23
    v_dot2_f32_bf16 v24, v69, v69, v24
    v_dot2_f32_bf16 v20, v70, v22, v20
    v_dot2_f32_bf16 v21, v70, v70, v21
    v_dot2_f32_bf16 v23, v71, v22, v23
    v_dot2_f32_bf16 v24, v71, v71, v24
    s_waitcnt vmcnt(21)
    v_dot2_f32_bf16 v20, v72, v22, v20
    v_dot2_f32_bf16 v21, v72, v72, v21
    v_dot2_f32_bf16 v23, v73, v22, v23
    v_dot2_f32_bf16 v24, v73, v73, v24
    v_dot2_f32_bf16 v20, v74, v22, v20
    v_dot2_f32_bf16 v21, v74, v74, v21
    v_dot2_f32_bf16 v23, v75, v22, v23
    v_dot2_f32_bf16 v24, v75, v75, v24
    s_waitcnt vmcnt(20)
    v_dot2_f32_bf16 v20, v76, v22, v20
    v_dot2_f32_bf16 v21, v76, v76, v21
    v_dot2_f32_bf16 v23, v77, v22, v23
    v_dot2_f32_bf16 v24, v77, v77, v24
    v_dot2_f32_bf16 v20, v78, v22, v20
    v_dot2_f32_bf16 v21, v78, v78, v21
    v_dot2_f32_bf16 v23, v79, v22, v23
    v_dot2_f32_bf16 v24, v79, v79, v24
    s_waitcnt vmcnt(19)
    v_dot2_f32_bf16 v20, v80, v22, v20
    v_dot2_f32_bf16 v21, v80, v80, v21
    v_dot2_f32_bf16 v23, v81, v22, v23
    v_dot2_f32_bf16 v24, v81, v81, v24
    v_dot2_f32_bf16 v20, v82, v22, v20
    v_dot2_f32_bf16 v21, v82, v82, v21
    v_dot2_f32_bf16 v23, v83, v22, v23
    v_dot2_f32_bf16 v24, v83, v83, v24
    s_waitcnt vmcnt(18)
    v_dot2_f32_bf16 v20, v84, v22, v20
    v_dot2_f32_bf16 v21, v84, v84, v21
    v_dot2_f32_bf16 v23, v85, v22, v23
    v_dot2_f32_bf16 v24, v85, v85, v24
    v_dot2_f32_bf16 v20, v86, v22, v20
    v_dot2_f32_bf16 v21, v86, v86, v21
    v_dot2_f32_bf16 v23, v87, v22, v23
    v_dot2_f32_bf16 v24, v87, v87, v24
    s_waitcnt vmcnt(17)
    v_dot2_f32_bf16 v20, v88, v22, v20
    v_dot2_f32_bf16 v21, v88, v88, v21
    v_dot2_f32_bf16 v23, v89, v22, v23
    v_dot2_f32_bf16 v24, v89, v89, v24
    v_dot2_f32_bf16 v20, v90, v22, v20
    v_dot2_f32_bf16 v21, v90, v90, v21
    v_dot2_f32_bf16 v23, v91, v22, v23
    v_dot2_f32_bf16 v24, v91, v91, v24
    s_waitcnt vmcnt(16)
    v_dot2_f32_bf16 v20, v92, v22, v20
    v_dot2_f32_bf16 v21, v92, v92, v21
    v_dot2_f32_bf16 v23, v93, v22, v23
    v_dot2_f32_bf16 v24, v93, v93, v24
    v_dot2_f32_bf16 v20, v94, v22, v20
    v_dot2_f32_bf16 v21, v94, v94, v21
    v_dot2_f32_bf16 v23, v95, v22, v23
    v_dot2_f32_bf16 v24, v95, v95, v24
    s_nop 1
    v_add_f32 v20, v20, v23
    v_add_f32 v21, v21, v24
    s_nop 0
    v_add_f32_dpp v20, v20, v20 quad_perm:[1,0,3,2] row_mask:0xf bank_mask:0xf
    v_add_f32_dpp v21, v21, v21 quad_perm:[1,0,3,2] row_mask:0xf bank_mask:0xf
    s_nop 0
    v_add_f32_dpp v20, v20, v20 quad_perm:[2,3,0,1] row_mask:0xf bank_mask:0xf
    v_add_f32_dpp v21, v21, v21 quad_perm:[2,3,0,1] row_mask:0xf bank_mask:0xf
    s_nop 0
    v_add_f32_dpp v20, v20, v20 row_half_mirror row_mask:0xf bank_mask:0xf
    v_add_f32_dpp v21, v21, v21 row_half_mirror row_mask:0xf bank_mask:0xf
    v_mul_f32 v20, 0x3b000000, v20
    v_mul_f32 v21, 0x3b000000, v21
    v_fma_f32 v21, -v20, v20, v21
    v_max_f32 v21, 0, v21
    v_cvt_pk_bf16_f32 v20, v20, v20
    v_and_b32 v20, 0xffff0000, v20
    v_cvt_pk_bf16_f32 v21, v21, v21
    v_and_b32 v21, 0xffff0000, v21
    v_add_f32 v21, 0x3727c5ac, v21
    v_cvt_pk_bf16_f32 v21, v21, v21
    v_and_b32 v21, 0xffff0000, v21
    v_sqrt_f32 v21, v21
    s_nop 0
    v_cvt_pk_bf16_f32 v21, v21, v21
    v_and_b32 v21, 0xffff0000, v21
    v_rcp_f32 v21, v21
    ds_bpermute_b32 v20, v50, v20
    ds_bpermute_b32 v21, v50, v21
    s_waitcnt vmcnt(12) lgkmcnt(0)
    v_lshlrev_b32 v24, 16, v96
    v_and_b32 v25, 0xffff0000, v96
    v_lshlrev_b32 v26, 16, v97
    v_and_b32 v27, 0xffff0000, v97
    v_lshlrev_b32 v28, 16, v98
    v_and_b32 v29, 0xffff0000, v98
    v_lshlrev_b32 v30, 16, v99
    v_and_b32 v31, 0xffff0000, v99
    v_sub_f32 v24, v24, v20
    v_sub_f32 v25, v25, v20
    v_sub_f32 v26, v26, v20
    v_sub_f32 v27, v27, v20
    v_sub_f32 v28, v28, v20
    v_sub_f32 v29, v29, v20
    v_sub_f32 v30, v30, v20
    v_sub_f32 v31, v31, v20
    v_cvt_pk_bf16_f32 v32, v24, v25
    v_cvt_pk_bf16_f32 v33, v26, v27
    v_cvt_pk_bf16_f32 v34, v28, v29
    v_cvt_pk_bf16_f32 v35, v30, v31
    v_lshlrev_b32 v24, 16, v32
    v_and_b32 v25, 0xffff0000, v32
    v_lshlrev_b32 v26, 16, v33
    v_and_b32 v27, 0xffff0000, v33
    v_lshlrev_b32 v28, 16, v34
    v_and_b32 v29, 0xffff0000, v34
    v_lshlrev_b32 v30, 16, v35
    v_and_b32 v31, 0xffff0000, v35
    v_mul_f32 v24, v24, v21
    v_mul_f32 v25, v25, v21
    v_mul_f32 v26, v26, v21
    v_mul_f32 v27, v27, v21
    v_mul_f32 v28, v28, v21
    v_mul_f32 v29, v29, v21
    v_mul_f32 v30, v30, v21
    v_mul_f32 v31, v31, v21
    v_cvt_pk_bf16_f32 v32, v24, v25
    v_cvt_pk_bf16_f32 v33, v26, v27
    v_cvt_pk_bf16_f32 v34, v28, v29
    v_cvt_pk_bf16_f32 v35, v30, v31
    v_lshlrev_b32 v24, 16, v32
    v_and_b32 v25, 0xffff0000, v32
    v_lshlrev_b32 v26, 16, v33
    v_and_b32 v27, 0xffff0000, v33
    v_lshlrev_b32 v28, 16, v34
    v_and_b32 v29, 0xffff0000, v34
    v_lshlrev_b32 v30, 16, v35
    v_and_b32 v31, 0xffff0000, v35
    v_cvt_f16_f32 v24, v24
    v_cvt_f16_f32 v25, v25
    v_cvt_f16_f32 v26, v26
    v_cvt_f16_f32 v27, v27
    v_cvt_f16_f32 v28, v28
    v_cvt_f16_f32 v29, v29
    v_cvt_f16_f32 v30, v30
    v_cvt_f16_f32 v31, v31
    v_pack_b32_f16 v112, v24, v25
    v_pack_b32_f16 v113, v26, v27
    v_pack_b32_f16 v114, v28, v29
    v_pack_b32_f16 v115, v30, v31
    buffer_store_dwordx4 v[112:115], v48, s[48:51], s60 offen offset:0
    v_lshlrev_b32 v24, 16, v100
    v_and_b32 v25, 0xffff0000, v100
    v_lshlrev_b32 v26, 16, v101
    v_and_b32 v27, 0xffff0000, v101
    v_lshlrev_b32 v28, 16, v102
    v_and_b32 v29, 0xffff0000, v102
    v_lshlrev_b32 v30, 16, v103
    v_and_b32 v31, 0xffff0000, v103
    v_sub_f32 v24, v24, v20
    v_sub_f32 v25, v25, v20
    v_sub_f32 v26, v26, v20
    v_sub_f32 v27, v27, v20
    v_sub_f32 v28, v28, v20
    v_sub_f32 v29, v29, v20
    v_sub_f32 v30, v30, v20
    v_sub_f32 v31, v31, v20
    v_cvt_pk_bf16_f32 v32, v24, v25
    v_cvt_pk_bf16_f32 v33, v26, v27
    v_cvt_pk_bf16_f32 v34, v28, v29
    v_cvt_pk_bf16_f32 v35, v30, v31
    v_lshlrev_b32 v24, 16, v32
    v_and_b32 v25, 0xffff0000, v32
    v_lshlrev_b32 v26, 16, v33
    v_and_b32 v27, 0xffff0000, v33
    v_lshlrev_b32 v28, 16, v34
    v_and_b32 v29, 0xffff0000, v34
    v_lshlrev_b32 v30, 16, v35
    v_and_b32 v31, 0xffff0000, v35
    v_mul_f32 v24, v24, v21
    v_mul_f32 v25, v25, v21
    v_mul_f32 v26, v26, v21
    v_mul_f32 v27, v27, v21
    v_mul_f32 v28, v28, v21
    v_mul_f32 v29, v29, v21
    v_mul_f32 v30, v30, v21
    v_mul_f32 v31, v31, v21
    v_cvt_pk_bf16_f32 v32, v24, v25
    v_cvt_pk_bf16_f32 v33, v26, v27
    v_cvt_pk_bf16_f32 v34, v28, v29
    v_cvt_pk_bf16_f32 v35, v30, v31
    v_lshlrev_b32 v24, 16, v32
    v_and_b32 v25, 0xffff0000, v32
    v_lshlrev_b32 v26, 16, v33
    v_and_b32 v27, 0xffff0000, v33
    v_lshlrev_b32 v28, 16, v34
    v_and_b32 v29, 0xffff0000, v34
    v_lshlrev_b32 v30, 16, v35
    v_and_b32 v31, 0xffff0000, v35
    v_cvt_f16_f32 v24, v24
    v_cvt_f16_f32 v25, v25
    v_cvt_f16_f32 v26, v26
    v_cvt_f16_f32 v27, v27
    v_cvt_f16_f32 v28, v28
    v_cvt_f16_f32 v29, v29
    v_cvt_f16_f32 v30, v30
    v_cvt_f16_f32 v31, v31
    v_pack_b32_f16 v116, v24, v25
    v_pack_b32_f16 v117, v26, v27
    v_pack_b32_f16 v118, v28, v29
    v_pack_b32_f16 v119, v30, v31
    buffer_store_dwordx4 v[116:119], v48, s[48:51], s60 offen offset:2048
    v_lshlrev_b32 v24, 16, v104
    v_and_b32 v25, 0xffff0000, v104
    v_lshlrev_b32 v26, 16, v105
    v_and_b32 v27, 0xffff0000, v105
    v_lshlrev_b32 v28, 16, v106
    v_and_b32 v29, 0xffff0000, v106
    v_lshlrev_b32 v30, 16, v107
    v_and_b32 v31, 0xffff0000, v107
    v_sub_f32 v24, v24, v20
    v_sub_f32 v25, v25, v20
    v_sub_f32 v26, v26, v20
    v_sub_f32 v27, v27, v20
    v_sub_f32 v28, v28, v20
    v_sub_f32 v29, v29, v20
    v_sub_f32 v30, v30, v20
    v_sub_f32 v31, v31, v20
    v_cvt_pk_bf16_f32 v32, v24, v25
    v_cvt_pk_bf16_f32 v33, v26, v27
    v_cvt_pk_bf16_f32 v34, v28, v29
    v_cvt_pk_bf16_f32 v35, v30, v31
    v_lshlrev_b32 v24, 16, v32
    v_and_b32 v25, 0xffff0000, v32
    v_lshlrev_b32 v26, 16, v33
    v_and_b32 v27, 0xffff0000, v33
    v_lshlrev_b32 v28, 16, v34
    v_and_b32 v29, 0xffff0000, v34
    v_lshlrev_b32 v30, 16, v35
    v_and_b32 v31, 0xffff0000, v35
    v_mul_f32 v24, v24, v21
    v_mul_f32 v25, v25, v21
    v_mul_f32 v26, v26, v21
    v_mul_f32 v27, v27, v21
    v_mul_f32 v28, v28, v21
    v_mul_f32 v29, v29, v21
    v_mul_f32 v30, v30, v21
    v_mul_f32 v31, v31, v21
    v_cvt_pk_bf16_f32 v32, v24, v25
    v_cvt_pk_bf16_f32 v33, v26, v27
    v_cvt_pk_bf16_f32 v34, v28, v29
    v_cvt_pk_bf16_f32 v35, v30, v31
    v_lshlrev_b32 v24, 16, v32
    v_and_b32 v25, 0xffff0000, v32
    v_lshlrev_b32 v26, 16, v33
    v_and_b32 v27, 0xffff0000, v33
    v_lshlrev_b32 v28, 16, v34
    v_and_b32 v29, 0xffff0000, v34
    v_lshlrev_b32 v30, 16, v35
    v_and_b32 v31, 0xffff0000, v35
    v_cvt_f16_f32 v24, v24
    v_cvt_f16_f32 v25, v25
    v_cvt_f16_f32 v26, v26
    v_cvt_f16_f32 v27, v27
    v_cvt_f16_f32 v28, v28
    v_cvt_f16_f32 v29, v29
    v_cvt_f16_f32 v30, v30
    v_cvt_f16_f32 v31, v31
    v_pack_b32_f16 v120, v24, v25
    v_pack_b32_f16 v121, v26, v27
    v_pack_b32_f16 v122, v28, v29
    v_pack_b32_f16 v123, v30, v31
    buffer_store_dwordx4 v[120:123], v49, s[48:51], s60 offen offset:0
    v_lshlrev_b32 v24, 16, v108
    v_and_b32 v25, 0xffff0000, v108
    v_lshlrev_b32 v26, 16, v109
    v_and_b32 v27, 0xffff0000, v109
    v_lshlrev_b32 v28, 16, v110
    v_and_b32 v29, 0xffff0000, v110
    v_lshlrev_b32 v30, 16, v111
    v_and_b32 v31, 0xffff0000, v111
    v_sub_f32 v24, v24, v20
    v_sub_f32 v25, v25, v20
    v_sub_f32 v26, v26, v20
    v_sub_f32 v27, v27, v20
    v_sub_f32 v28, v28, v20
    v_sub_f32 v29, v29, v20
    v_sub_f32 v30, v30, v20
    v_sub_f32 v31, v31, v20
    v_cvt_pk_bf16_f32 v32, v24, v25
    v_cvt_pk_bf16_f32 v33, v26, v27
    v_cvt_pk_bf16_f32 v34, v28, v29
    v_cvt_pk_bf16_f32 v35, v30, v31
    v_lshlrev_b32 v24, 16, v32
    v_and_b32 v25, 0xffff0000, v32
    v_lshlrev_b32 v26, 16, v33
    v_and_b32 v27, 0xffff0000, v33
    v_lshlrev_b32 v28, 16, v34
    v_and_b32 v29, 0xffff0000, v34
    v_lshlrev_b32 v30, 16, v35
    v_and_b32 v31, 0xffff0000, v35
    v_mul_f32 v24, v24, v21
    v_mul_f32 v25, v25, v21
    v_mul_f32 v26, v26, v21
    v_mul_f32 v27, v27, v21
    v_mul_f32 v28, v28, v21
    v_mul_f32 v29, v29, v21
    v_mul_f32 v30, v30, v21
    v_mul_f32 v31, v31, v21
    v_cvt_pk_bf16_f32 v32, v24, v25
    v_cvt_pk_bf16_f32 v33, v26, v27
    v_cvt_pk_bf16_f32 v34, v28, v29
    v_cvt_pk_bf16_f32 v35, v30, v31
    v_lshlrev_b32 v24, 16, v32
    v_and_b32 v25, 0xffff0000, v32
    v_lshlrev_b32 v26, 16, v33
    v_and_b32 v27, 0xffff0000, v33
    v_lshlrev_b32 v28, 16, v34
    v_and_b32 v29, 0xffff0000, v34
    v_lshlrev_b32 v30, 16, v35
    v_and_b32 v31, 0xffff0000, v35
    v_cvt_f16_f32 v24, v24
    v_cvt_f16_f32 v25, v25
    v_cvt_f16_f32 v26, v26
    v_cvt_f16_f32 v27, v27
    v_cvt_f16_f32 v28, v28
    v_cvt_f16_f32 v29, v29
    v_cvt_f16_f32 v30, v30
    v_cvt_f16_f32 v31, v31
    v_pack_b32_f16 v124, v24, v25
    v_pack_b32_f16 v125, v26, v27
    v_pack_b32_f16 v126, v28, v29
    v_pack_b32_f16 v127, v30, v31
    buffer_store_dwordx4 v[124:127], v49, s[48:51], s60 offen offset:2048
    s_waitcnt vmcnt(4)
    s_nop 2
    s_branch J_12
    s_nop 1
W23_11:
    s_waitcnt vmcnt(16)
    v_lshlrev_b32 v16, 16, v16
    v_lshlrev_b32 v17, 16, v17
    v_lshlrev_b32 v18, 16, v18
    v_lshlrev_b32 v19, 16, v19
    v_lshlrev_b32 v20, 16, v20
    v_lshlrev_b32 v21, 16, v21
    v_lshlrev_b32 v22, 16, v22
    v_lshlrev_b32 v23, 16, v23
    v_mul_f32 v24, 0xbfb8aa3b, v16
    v_mul_f32 v25, 0xbfb8aa3b, v17
    v_mul_f32 v26, 0xbfb8aa3b, v18
    v_mul_f32 v27, 0xbfb8aa3b, v19
    v_mul_f32 v28, 0xbfb8aa3b, v20
    v_mul_f32 v29, 0xbfb8aa3b, v21
    v_mul_f32 v30, 0xbfb8aa3b, v22
    v_mul_f32 v31, 0xbfb8aa3b, v23
    v_exp_f32 v24, v24
    v_exp_f32 v25, v25
    v_exp_f32 v26, v26
    v_exp_f32 v27, v27
    v_exp_f32 v28, v28
    v_exp_f32 v29, v29
    v_exp_f32 v30, v30
    v_exp_f32 v31, v31
    v_add_f32 v24, 1.0, v24
    v_add_f32 v25, 1.0, v25
    v_add_f32 v26, 1.0, v26
    v_add_f32 v27, 1.0, v27
    v_add_f32 v28, 1.0, v28
    v_add_f32 v29, 1.0, v29
    v_add_f32 v30, 1.0, v30
    v_add_f32 v31, 1.0, v31
    v_rcp_f32 v24, v24
    v_rcp_f32 v25, v25
    v_rcp_f32 v26, v26
    v_rcp_f32 v27, v27
    v_rcp_f32 v28, v28
    v_rcp_f32 v29, v29
    v_rcp_f32 v30, v30
    v_rcp_f32 v31, v31
    v_mul_f32 v16, v16, v24
    v_mul_f32 v17, v17, v25
    v_mul_f32 v18, v18, v26
    v_mul_f32 v19, v19, v27
    v_mul_f32 v20, v20, v28
    v_mul_f32 v21, v21, v29
    v_mul_f32 v22, v22, v30
    v_mul_f32 v23, v23, v31
    v_cvt_pk_bf16_f32 v16, v16, v16
    v_cvt_pk_bf16_f32 v17, v17, v17
    v_cvt_pk_bf16_f32 v18, v18, v18
    v_cvt_pk_bf16_f32 v19, v19, v19
    v_cvt_pk_bf16_f32 v20, v20, v20
    v_cvt_pk_bf16_f32 v21, v21, v21
    v_cvt_pk_bf16_f32 v22, v22, v22
    v_cvt_pk_bf16_f32 v23, v23, v23
    v_and_b32 v100, 0xffff, v16
    v_and_b32 v101, 0xffff0000, v16
    v_and_b32 v102, 0xffff, v17
    v_and_b32 v103, 0xffff0000, v17
    v_and_b32 v104, 0xffff, v18
    v_and_b32 v105, 0xffff0000, v18
    v_and_b32 v106, 0xffff, v19
    v_and_b32 v107, 0xffff0000, v19
    v_and_b32 v108, 0xffff, v20
    v_and_b32 v109, 0xffff0000, v20
    v_and_b32 v110, 0xffff, v21
    v_and_b32 v111, 0xffff0000, v21
    v_and_b32 v112, 0xffff, v22
    v_and_b32 v113, 0xffff0000, v22
    v_and_b32 v114, 0xffff, v23
    v_and_b32 v115, 0xffff0000, v23
    v_mov_b32 v50, 0
    v_mov_b32 v51, 0
    v_mov_b32 v52, 0
    v_mov_b32 v53, 0
    v_mov_b32 v54, 0
    v_mov_b32 v55, 0
    v_mov_b32 v56, 0
    v_mov_b32 v57, 0
    s_waitcnt vmcnt(15)
    v_dot2_f32_bf16 v50, v64, v100, v50
    v_dot2_f32_bf16 v51, v64, v101, v51
    v_dot2_f32_bf16 v52, v65, v100, v52
    v_dot2_f32_bf16 v53, v65, v101, v53
    v_dot2_f32_bf16 v54, v66, v100, v54
    v_dot2_f32_bf16 v55, v66, v101, v55
    v_dot2_f32_bf16 v56, v67, v100, v56
    v_dot2_f32_bf16 v57, v67, v101, v57
    s_waitcnt vmcnt(14)
    v_dot2_f32_bf16 v50, v68, v102, v50
    v_dot2_f32_bf16 v51, v68, v103, v51
    v_dot2_f32_bf16 v52, v69, v102, v52
    v_dot2_f32_bf16 v53, v69, v103, v53
    v_dot2_f32_bf16 v54, v70, v102, v54
    v_dot2_f32_bf16 v55, v70, v103, v55
    v_dot2_f32_bf16 v56, v71, v102, v56
    v_dot2_f32_bf16 v57, v71, v103, v57
    s_waitcnt vmcnt(13)
    v_dot2_f32_bf16 v50, v72, v104, v50
    v_dot2_f32_bf16 v51, v72, v105, v51
    v_dot2_f32_bf16 v52, v73, v104, v52
    v_dot2_f32_bf16 v53, v73, v105, v53
    v_dot2_f32_bf16 v54, v74, v104, v54
    v_dot2_f32_bf16 v55, v74, v105, v55
    v_dot2_f32_bf16 v56, v75, v104, v56
    v_dot2_f32_bf16 v57, v75, v105, v57
    s_waitcnt vmcnt(12)
    v_dot2_f32_bf16 v50, v76, v106, v50
    v_dot2_f32_bf16 v51, v76, v107, v51
    v_dot2_f32_bf16 v52, v77, v106, v52
    v_dot2_f32_bf16 v53, v77, v107, v53
    v_dot2_f32_bf16 v54, v78, v106, v54
    v_dot2_f32_bf16 v55, v78, v107, v55
    v_dot2_f32_bf16 v56, v79, v106, v56
    v_dot2_f32_bf16 v57, v79, v107, v57
    s_waitcnt vmcnt(11)
    v_dot2_f32_bf16 v50, v80, v108, v50
    v_dot2_f32_bf16 v51, v80, v109, v51
    v_dot2_f32_bf16 v52, v81, v108, v52
    v_dot2_f32_bf16 v53, v81, v109, v53
    v_dot2_f32_bf16 v54, v82, v108, v54
    v_dot2_f32_bf16 v55, v82, v109, v55
    v_dot2_f32_bf16 v56, v83, v108, v56
    v_dot2_f32_bf16 v57, v83, v109, v57
    s_waitcnt vmcnt(10)
    v_dot2_f32_bf16 v50, v84, v110, v50
    v_dot2_f32_bf16 v51, v84, v111, v51
    v_dot2_f32_bf16 v52, v85, v110, v52
    v_dot2_f32_bf16 v53, v85, v111, v53
    v_dot2_f32_bf16 v54, v86, v110, v54
    v_dot2_f32_bf16 v55, v86, v111, v55
    v_dot2_f32_bf16 v56, v87, v110, v56
    v_dot2_f32_bf16 v57, v87, v111, v57
    s_waitcnt vmcnt(9)
    v_dot2_f32_bf16 v50, v88, v112, v50
    v_dot2_f32_bf16 v51, v88, v113, v51
    v_dot2_f32_bf16 v52, v89, v112, v52
    v_dot2_f32_bf16 v53, v89, v113, v53
    v_dot2_f32_bf16 v54, v90, v112, v54
    v_dot2_f32_bf16 v55, v90, v113, v55
    v_dot2_f32_bf16 v56, v91, v112, v56
    v_dot2_f32_bf16 v57, v91, v113, v57
    s_waitcnt vmcnt(8)
    v_dot2_f32_bf16 v50, v92, v114, v50
    v_dot2_f32_bf16 v51, v92, v115, v51
    v_dot2_f32_bf16 v52, v93, v114, v52
    v_dot2_f32_bf16 v53, v93, v115, v53
    v_dot2_f32_bf16 v54, v94, v114, v54
    v_dot2_f32_bf16 v55, v94, v115, v55
    v_dot2_f32_bf16 v56, v95, v114, v56
    v_dot2_f32_bf16 v57, v95, v115, v57
    v_add_f32_dpp v50, v50, v50 row_ror:4 row_mask:0xf bank_mask:0xf
    v_add_f32_dpp v51, v51, v51 row_ror:4 row_mask:0xf bank_mask:0xf
    v_add_f32_dpp v52, v52, v52 row_ror:4 row_mask:0xf bank_mask:0xf
    v_add_f32_dpp v53, v53, v53 row_ror:4 row_mask:0xf bank_mask:0xf
    v_add_f32_dpp v54, v54, v54 row_ror:4 row_mask:0xf bank_mask:0xf
    v_add_f32_dpp v55, v55, v55 row_ror:4 row_mask:0xf bank_mask:0xf
    v_add_f32_dpp v56, v56, v56 row_ror:4 row_mask:0xf bank_mask:0xf
    v_add_f32_dpp v57, v57, v57 row_ror:4 row_mask:0xf bank_mask:0xf
    v_add_f32_dpp v50, v50, v50 row_ror:8 row_mask:0xf bank_mask:0xf
    v_add_f32_dpp v51, v51, v51 row_ror:8 row_mask:0xf bank_mask:0xf
    v_add_f32_dpp v52, v52, v52 row_ror:8 row_mask:0xf bank_mask:0xf
    v_add_f32_dpp v53, v53, v53 row_ror:8 row_mask:0xf bank_mask:0xf
    v_add_f32_dpp v54, v54, v54 row_ror:8 row_mask:0xf bank_mask:0xf
    v_add_f32_dpp v55, v55, v55 row_ror:8 row_mask:0xf bank_mask:0xf
    v_add_f32_dpp v56, v56, v56 row_ror:8 row_mask:0xf bank_mask:0xf
    v_add_f32_dpp v57, v57, v57 row_ror:8 row_mask:0xf bank_mask:0xf
    v_permlane32_swap_b32 v50, v54
    v_permlane32_swap_b32 v51, v55
    v_permlane32_swap_b32 v52, v56
    v_permlane32_swap_b32 v53, v57
    v_add_f32 v50, v50, v54
    v_add_f32 v51, v51, v55
    v_add_f32 v52, v52, v56
    v_add_f32 v53, v53, v57
    s_nop 0
    v_permlane16_swap_b32 v50, v52
    v_permlane16_swap_b32 v51, v53
    v_add_f32 v50, v50, v52
    v_add_f32 v51, v51, v53
    v_lshlrev_b32 v28, 5, v8
    v_lshl_add_u32 v28, v3, 3, v28
    s_mul_i32 s58, s63, 12288
    s_lshl_b32 s59, s53, 7
    s_add_u32 s58, s58, s59
    s_add_u32 s58, s58, 65536
    s_cmp_ge_u32 s2, 192
    s_cselect_b32 s58, 0x7f000000, s58
    v_cmp_gt_u32 vcc, 4, v2
    s_nop 0
    s_mov_b64 exec, vcc
    buffer_store_dwordx2 v[50:51], v28, s[48:51], s58 offen
    s_mov_b64 exec, -1
    s_waitcnt vmcnt(1)
    s_nop 1
J_12:
    v_lshrrev_b32 v30, 2, v2
    v_lshl_add_u32 v30, v3, 3, v30
    v_lshlrev_b32 v30, 6, v30
    v_add_u32 v30, s70, v30
    v_and_b32 v31, 3, v2
    v_lshl_add_u32 v32, v31, 4, v30
    v_lshl_add_u32 v33, v31, 3, v30
    s_cmp_eq_u32 s80, 1
    s_cselect_b32 s6, 32, 8
    s_cselect_b64 vcc, -1, 0
    v_cndmask_b32 v34, v32, v33, vcc
    v_add_u32 v35, s6, v34
    ds_read_b64_tr_b16 v[64:65], v34 offset:0
    ds_read_b64_tr_b16 v[66:67], v34 offset:256
    ds_read_b64_tr_b16 v[68:69], v35 offset:0
    ds_read_b64_tr_b16 v[70:71], v35 offset:256
    ds_read_b64_tr_b16 v[72:73], v32 offset:2048
    ds_read_b64_tr_b16 v[74:75], v32 offset:2304
    ds_read_b64_tr_b16 v[76:77], v32 offset:2056
    ds_read_b64_tr_b16 v[78:79], v32 offset:2312
    s_waitcnt lgkmcnt(0)
    ds_read_b64_tr_b16 v[80:81], v32 offset:4096
    ds_read_b64_tr_b16 v[82:83], v32 offset:4352
    ds_read_b64_tr_b16 v[84:85], v32 offset:4104
    ds_read_b64_tr_b16 v[86:87], v32 offset:4360
    ds_read_b64_tr_b16 v[88:89], v32 offset:6144
    ds_read_b64_tr_b16 v[90:91], v32 offset:6400
    ds_read_b64_tr_b16 v[92:93], v32 offset:6152
    ds_read_b64_tr_b16 v[94:95], v32 offset:6408
    s_waitcnt lgkmcnt(0)
    buffer_store_dwordx4 v[64:67], v4, s[48:51], s72 offen
    buffer_store_dwordx4 v[68:71], v4, s[48:51], s73 offen
    buffer_store_dwordx4 v[72:75], v4, s[48:51], s74 offen
    buffer_store_dwordx4 v[76:79], v4, s[48:51], s75 offen
    buffer_store_dwordx4 v[80:83], v4, s[48:51], s76 offen
    buffer_store_dwordx4 v[84:87], v4, s[48:51], s77 offen
    buffer_store_dwordx4 v[88:91], v4, s[48:51], s78 offen
    buffer_store_dwordx4 v[92:95], v4, s[48:51], s79 offen
    s_getpc_b64 s[88:89]
    s_nop 1
L_pc_k0:
    s_add_u32 s88, s88, k1_kernel-L_pc_k0
    s_addc_u32 s89, s89, 0
    v_lshlrev_b32 v40, 7, v1
    s_lshl_b32 s6, s3, 14
    v_add_u32 v40, s6, v40
    v_add_u32 v41, 0x2000, v40
    s_mov_b32 s6, L_codeend-k1_kernel-4
    v_min_u32 v40, s6, v40
    v_min_u32 v41, s6, v41
    global_load_dword v42, v40, s[88:89]
    global_load_dword v43, v41, s[88:89]
    s_endpgm
.globl k1_kernel
.p2align 8
.type k1_kernel,@function
k1_kernel:
    s_cmp_lt_u32 s2, 256
    s_nop 1
    s_cbranch_scc1 L_go_k1_kernel
    s_endpgm
    s_nop 1
L_go_k1_kernel:
    s_load_dwordx16 s[64:79], s[0:1], 0
    s_load_dwordx8 s[80:87], s[0:1], 64
    v_and_b32 v1, 63, v0
    v_and_b32 v2, 15, v0
    v_bfe_u32 v3, v0, 4, 2
    v_lshrrev_b32 v4, 6, v0
    s_nop 0
    v_readfirstlane_b32 s3, v4
    v_lshlrev_b32 v4, 4, v1
    s_bfe_u32 s4, s2, 0x20001
    s_lshl_b32 s4, s4, 2
    s_lshr_b32 s5, s2, 6
    s_or_b32 s4, s4, s5
    s_and_b32 s5, s2, 1
    s_lshl_b32 s5, s5, 3
    s_bfe_u32 s6, s2, 0x30003
    s_or_b32 s5, s5, s6
    s_waitcnt lgkmcnt(0)
    s_mov_b32 s8, s64
    s_and_b32 s9, s65, 0xffff
    s_mov_b32 s10, 0x200000
    s_mov_b32 s11, 0x20000
    s_mov_b32 s40, s82
    s_and_b32 s41, s83, 0xffff
    s_mov_b32 s42, 0x200000
    s_mov_b32 s43, 0x20000
    s_mov_b32 s48, s86
    s_and_b32 s49, s87, 0xffff
    s_mov_b32 s50, 0x10000000
    s_mov_b32 s51, 0x20000
    s_mov_b32 s94, s68
    s_and_b32 s95, s69, 0xffff
    s_mov_b32 s96, s72
    s_and_b32 s97, s73, 0xffff
    s_mov_b32 s98, s74
    s_and_b32 s99, s75, 0xffff
    s_mov_b32 s100, s76
    s_and_b32 s101, s77, 0xffff
    s_mul_i32 s65, s5, 0x5556
    s_lshr_b32 s65, s65, 13
    s_lshl_b32 s6, s4, 7
    s_lshr_b32 s7, s5, 3
    s_lshl_b32 s7, s7, 6
    s_add_u32 s66, s6, s7
    s_and_b32 s71, s5, 7
    s_lshl_b32 s67, s71, 6
    s_lshl_b32 s68, s4, 10
    s_lshl_b32 s64, s5, 10
    s_lshl_b32 s6, s4, 3
    s_lshl_b32 s7, s3, 1
    s_add_u32 s69, s6, s7
    s_lshl_b32 s70, s3, 12
    s_lshl_b32 s76, s3, 10
    s_mov_b32 s77, s5
    v_lshlrev_b32 v28, 3, v0
    s_mov_b32 s6, 65536
    buffer_load_dwordx2 v[64:65], v28, s[48:51], s6 offen offset:0
    buffer_load_dwordx2 v[66:67], v28, s[48:51], s6 offen offset:2048
    s_mov_b32 s6, 77824
    buffer_load_dwordx2 v[68:69], v28, s[48:51], s6 offen offset:0
    buffer_load_dwordx2 v[70:71], v28, s[48:51], s6 offen offset:2048
    s_mov_b32 s6, 90112
    buffer_load_dwordx2 v[72:73], v28, s[48:51], s6 offen offset:0
    buffer_load_dwordx2 v[74:75], v28, s[48:51], s6 offen offset:2048
    s_mov_b32 s6, 102400
    buffer_load_dwordx2 v[76:77], v28, s[48:51], s6 offen offset:0
    buffer_load_dwordx2 v[78:79], v28, s[48:51], s6 offen offset:2048
    s_lshl_b32 s12, s77, 10
    s_add_u32 s13, s12, 1024
    s_and_b32 s13, s13, 0x3fff
    s_mul_i32 s6, s5, 98304
    s_add_u32 s6, s6, 22020096
    v_add_u32 v20, s6, v4
    v_add_u32 v21, 16384, v20
    v_add_u32 v22, 32768, v20
    v_add_u32 v23, 49152, v20
    v_add_u32 v24, 65536, v20
    v_add_u32 v25, 81920, v20
    s_add_u32 s28, s12, s76
    s_and_b32 s28, s28, 0x3fff
    s_mul_i32 s33, s3, 6144
    s_add_u32 m0, s33, 0
    s_nop 0
    buffer_load_dwordx4 v20, s[48:51], s28 offen lds
    s_add_u32 m0, s33, 1024
    s_nop 0
    buffer_load_dwordx4 v21, s[48:51], s28 offen lds
    s_add_u32 m0, s33, 2048
    s_nop 0
    buffer_load_dwordx4 v22, s[48:51], s28 offen lds
    s_add_u32 m0, s33, 3072
    s_nop 0
    buffer_load_dwordx4 v23, s[48:51], s28 offen lds
    s_add_u32 m0, s33, 4096
    s_nop 0
    buffer_load_dwordx4 v24, s[48:51], s28 offen lds
    s_add_u32 m0, s33, 5120
    s_nop 0
    buffer_load_dwordx4 v25, s[48:51], s28 offen lds
    s_lshl_b32 s6, s69, 14
    s_add_u32 s6, s6, 1048576
    v_add_u32 v16, s6, v4
    v_add_u32 v17, 0x4000, v16
    buffer_load_dwordx4 v[128:131], v16, s[48:51], s12 offen
    buffer_load_dwordx4 v[132:135], v17, s[48:51], s12 offen
    buffer_load_dwordx4 v[136:139], v16, s[48:51], s13 offen
    buffer_load_dwordx4 v[140:143], v17, s[48:51], s13 offen
    s_add_u32 s14, s13, 1024
    s_and_b32 s14, s14, 0x3fff
    s_add_u32 s15, s14, 1024
    s_and_b32 s15, s15, 0x3fff
    s_add_u32 s16, s15, 1024
    s_and_b32 s16, s16, 0x3fff
    s_add_u32 s17, s16, 1024
    s_and_b32 s17, s17, 0x3fff
    s_add_u32 s18, s17, 1024
    s_and_b32 s18, s18, 0x3fff
    s_add_u32 s19, s18, 1024
    s_and_b32 s19, s19, 0x3fff
    s_add_u32 s20, s19, 1024
    s_and_b32 s20, s20, 0x3fff
    s_add_u32 s21, s20, 1024
    s_and_b32 s21, s21, 0x3fff
    s_add_u32 s22, s21, 1024
    s_and_b32 s22, s22, 0x3fff
    s_add_u32 s23, s22, 1024
    s_and_b32 s23, s23, 0x3fff
    s_add_u32 s24, s23, 1024
    s_and_b32 s24, s24, 0x3fff
    s_add_u32 s25, s24, 1024
    s_and_b32 s25, s25, 0x3fff
    s_add_u32 s26, s25, 1024
    s_and_b32 s26, s26, 0x3fff
    s_add_u32 s27, s26, 1024
    s_and_b32 s27, s27, 0x3fff
    s_add_u32 s29, s28, 4096
    s_and_b32 s29, s29, 0x3fff
    s_add_u32 s30, s29, 4096
    s_and_b32 s30, s30, 0x3fff
    s_add_u32 s31, s30, 4096
    s_and_b32 s31, s31, 0x3fff
    s_add_u32 m0, s33, 24576
    s_nop 0
    buffer_load_dwordx4 v20, s[48:51], s29 offen lds
    s_add_u32 m0, s33, 25600
    s_nop 0
    buffer_load_dwordx4 v21, s[48:51], s29 offen lds
    s_add_u32 m0, s33, 26624
    s_nop 0
    buffer_load_dwordx4 v22, s[48:51], s29 offen lds
    s_add_u32 m0, s33, 27648
    s_nop 0
    buffer_load_dwordx4 v23, s[48:51], s29 offen lds
    s_add_u32 m0, s33, 28672
    s_nop 0
    buffer_load_dwordx4 v24, s[48:51], s29 offen lds
    s_add_u32 m0, s33, 29696
    s_nop 0
    buffer_load_dwordx4 v25, s[48:51], s29 offen lds
    buffer_load_dwordx4 v[144:147], v16, s[48:51], s14 offen
    buffer_load_dwordx4 v[148:151], v17, s[48:51], s14 offen
    buffer_load_dwordx4 v[152:155], v16, s[48:51], s15 offen
    buffer_load_dwordx4 v[156:159], v17, s[48:51], s15 offen
    buffer_load_dwordx4 v[160:163], v16, s[48:51], s16 offen
    buffer_load_dwordx4 v[164:167], v17, s[48:51], s16 offen
    s_lshl_b32 s6, s77, 4
    v_subrev_u32 v29, s6, v0
    v_and_b32 v29, 0xff, v29
    v_lshrrev_b32 v30, 2, v29
    v_lshlrev_b32 v30, 6, v30
    v_and_b32 v29, 3, v29
    v_lshl_add_u32 v30, v29, 3, v30
    v_add_u32 v30, 147456, v30
    v_add_u32 v19, 0x10000, v4
    v_lshlrev_b32 v26, 6, v3
    v_add_u32 v26, 147456, v26
    s_waitcnt vmcnt(22)
    v_add_f32 v64, v64, v68
    v_add_f32 v72, v72, v76
    v_add_f32 v65, v65, v69
    v_add_f32 v73, v73, v77
    v_add_f32 v66, v66, v70
    v_add_f32 v74, v74, v78
    v_add_f32 v67, v67, v71
    v_add_f32 v75, v75, v79
    v_add_f32 v64, v64, v72
    v_add_f32 v65, v65, v73
    v_add_f32 v66, v66, v74
    v_add_f32 v67, v67, v75
    v_cvt_pk_bf16_f32 v64, v64, v64
    v_and_b32 v64, 0xffff0000, v64
    v_cvt_pk_bf16_f32 v65, v65, v65
    v_and_b32 v65, 0xffff0000, v65
    v_cvt_pk_bf16_f32 v66, v66, v66
    v_and_b32 v66, 0xffff0000, v66
    v_cvt_pk_bf16_f32 v67, v67, v67
    v_and_b32 v67, 0xffff0000, v67
    v_add_f32 v66, 1.0, v66
    v_cvt_pk_bf16_f32 v66, v66, v66
    v_and_b32 v66, 0xffff0000, v66
    v_add_f32 v67, 1.0, v67
    v_cvt_pk_bf16_f32 v67, v67, v67
    v_and_b32 v67, 0xffff0000, v67
    ds_write_b64 v30, v[66:67]
    ds_write_b64 v30, v[64:65] offset:32
    v_and_b32 v29, 31, v1
    v_lshrrev_b32 v31, 5, v1
    v_lshlrev_b32 v31, 11, v31
    v_lshl_add_u32 v29, v29, 2, v31
    s_lshl_b32 s35, s4, 7
    s_add_u32 s6, s35, 71680
    buffer_load_dword a144, v29, s[48:51], s6 offen
    s_add_u32 s6, s35, 83968
    buffer_load_dword a145, v29, s[48:51], s6 offen
    s_add_u32 s6, s35, 96256
    buffer_load_dword a146, v29, s[48:51], s6 offen
    s_add_u32 s6, s35, 108544
    buffer_load_dword a147, v29, s[48:51], s6 offen
    v_lshlrev_b32 v29, 2, v1
    s_cmp_eq_u32 s3, 2
    s_cselect_b32 s6, 5, 2
    s_cmp_eq_u32 s3, 3
    s_cselect_b32 s6, 4, s6
    s_lshl_b32 s6, s6, 9
    s_add_u32 s6, s6, s67
    s_lshl_b32 s35, s6, 2
    s_add_u32 s6, s35, 65536
    buffer_load_dword a148, v29, s[48:51], s6 offen
    s_add_u32 s6, s35, 77824
    buffer_load_dword a149, v29, s[48:51], s6 offen
    s_add_u32 s6, s35, 90112
    buffer_load_dword a150, v29, s[48:51], s6 offen
    s_add_u32 s6, s35, 102400
    buffer_load_dword a151, v29, s[48:51], s6 offen
    s_max_u32 s6, s3, 1
    s_sub_u32 s6, s6, 1
    s_add_u32 s6, s6, s65
    s_lshl_b32 s6, s6, 16
    s_lshl_b32 s7, s4, 10
    s_add_u32 s6, s6, s7
    s_add_u32 s6, s6, 17825792
    s_add_u32 s7, s6, 0
    buffer_load_dwordx4 a[152:155], v4, s[48:51], s7 offen
    s_add_u32 s7, s6, 16384
    buffer_load_dwordx4 a[156:159], v4, s[48:51], s7 offen
    s_add_u32 s7, s6, 32768
    buffer_load_dwordx4 a[160:163], v4, s[48:51], s7 offen
    s_add_u32 s7, s6, 49152
    buffer_load_dwordx4 a[164:167], v4, s[48:51], s7 offen
    s_lshl_b32 s6, s4, 17
    s_add_u32 s6, s6, 1032192
    s_cmp_eq_u32 s4, 0
    s_cselect_b32 s6, 0x7f000000, s6
    v_add_u32 v18, s6, v4
    s_lshl_b32 s6, s3, 12
    s_add_u32 s6, s6, s12
    s_add_u32 s6, s6, 0
    s_and_b32 s82, s6, 0x3fff
    s_lshl_b32 s6, s3, 12
    s_add_u32 s6, s6, s12
    s_add_u32 s6, s6, 1024
    s_and_b32 s83, s6, 0x3fff
    s_lshl_b32 s6, s3, 12
    s_add_u32 s6, s6, s12
    s_add_u32 s6, s6, 2048
    s_and_b32 s84, s6, 0x3fff
    s_lshl_b32 s6, s3, 12
    s_add_u32 s6, s6, s12
    s_add_u32 s6, s6, 3072
    s_and_b32 s85, s6, 0x3fff
    v_mov_b32 v32, 0xf149f2ca
    s_or_b32 s6, s4, s3
    s_cmp_eq_u32 s6, 0
    s_cselect_b32 s7, 64, 0
    v_lshl_add_u32 v33, v3, 2, 0
    v_sub_u32 v33, v2, v33
    v_and_b32 v34, 0x80000001, v33
    v_cmp_eq_u32 vcc, 0, v34
    s_nop 1
    v_cndmask_b32 v35, v32, 0, vcc
    v_accvgpr_write_b32 a240, v35
    v_add_u32 v33, 16, v33
    v_and_b32 v34, 1, v33
    v_lshl_add_u32 v34, v34, 6, v33
    v_cmp_gt_u32 vcc, 15, v34
    s_nop 1
    v_cndmask_b32 v35, v32, 0, vcc
    v_accvgpr_write_b32 a244, v35
    v_add_u32 v34, s7, v34
    v_cmp_gt_u32 vcc, 15, v34
    s_nop 1
    v_cndmask_b32 v35, v32, 0, vcc
    v_accvgpr_write_b32 a248, v35
    v_lshl_add_u32 v33, v3, 2, 1
    v_sub_u32 v33, v2, v33
    v_and_b32 v34, 0x80000001, v33
    v_cmp_eq_u32 vcc, 0, v34
    s_nop 1
    v_cndmask_b32 v35, v32, 0, vcc
    v_accvgpr_write_b32 a241, v35
    v_add_u32 v33, 16, v33
    v_and_b32 v34, 1, v33
    v_lshl_add_u32 v34, v34, 6, v33
    v_cmp_gt_u32 vcc, 15, v34
    s_nop 1
    v_cndmask_b32 v35, v32, 0, vcc
    v_accvgpr_write_b32 a245, v35
    v_add_u32 v34, s7, v34
    v_cmp_gt_u32 vcc, 15, v34
    s_nop 1
    v_cndmask_b32 v35, v32, 0, vcc
    v_accvgpr_write_b32 a249, v35
    v_lshl_add_u32 v33, v3, 2, 2
    v_sub_u32 v33, v2, v33
    v_and_b32 v34, 0x80000001, v33
    v_cmp_eq_u32 vcc, 0, v34
    s_nop 1
    v_cndmask_b32 v35, v32, 0, vcc
    v_accvgpr_write_b32 a242, v35
    v_add_u32 v33, 16, v33
    v_and_b32 v34, 1, v33
    v_lshl_add_u32 v34, v34, 6, v33
    v_cmp_gt_u32 vcc, 15, v34
    s_nop 1
    v_cndmask_b32 v35, v32, 0, vcc
    v_accvgpr_write_b32 a246, v35
    v_add_u32 v34, s7, v34
    v_cmp_gt_u32 vcc, 15, v34
    s_nop 1
    v_cndmask_b32 v35, v32, 0, vcc
    v_accvgpr_write_b32 a250, v35
    v_lshl_add_u32 v33, v3, 2, 3
    v_sub_u32 v33, v2, v33
    v_and_b32 v34, 0x80000001, v33
    v_cmp_eq_u32 vcc, 0, v34
    s_nop 1
    v_cndmask_b32 v35, v32, 0, vcc
    v_accvgpr_write_b32 a243, v35
    v_add_u32 v33, 16, v33
    v_and_b32 v34, 1, v33
    v_lshl_add_u32 v34, v34, 6, v33
    v_cmp_gt_u32 vcc, 15, v34
    s_nop 1
    v_cndmask_b32 v35, v32, 0, vcc
    v_accvgpr_write_b32 a247, v35
    v_add_u32 v34, s7, v34
    v_cmp_gt_u32 vcc, 15, v34
    s_nop 1
    v_cndmask_b32 v35, v32, 0, vcc
    v_accvgpr_write_b32 a251, v35
    s_mul_i32 s44, s71, 65536
    s_add_u32 s44, s44, 24117248
    v_add_u32 v8, s44, v4
    s_and_b32 s80, s5, 3
    s_mul_i32 s81, s3, 4
    s_add_u32 s36, s80, 0
    s_and_b32 s36, s36, 3
    s_add_u32 s36, s36, s81
    s_lshl_b32 s36, s36, 10
    s_add_u32 s37, s80, 1
    s_and_b32 s37, s37, 3
    s_add_u32 s37, s37, s81
    s_lshl_b32 s37, s37, 10
    s_add_u32 s38, s80, 2
    s_and_b32 s38, s38, 3
    s_add_u32 s38, s38, s81
    s_lshl_b32 s38, s38, 10
    s_add_u32 s39, s80, 3
    s_and_b32 s39, s39, 3
    s_add_u32 s39, s39, s81
    s_lshl_b32 s39, s39, 10
    s_mul_i32 s72, s71, 176128
    s_add_u32 s72, s72, 25165824
    v_add_u32 v9, s72, v4
    s_mov_b32 s80, s71
    s_mul_i32 s81, s3, 11
    s_add_u32 s7, s3, 0
    s_mul_i32 s7, s7, 0x5556
    s_lshr_b32 s7, s7, 13
    s_lshl_b32 s52, s7, 10
    s_add_u32 s7, s3, 4
    s_mul_i32 s7, s7, 0x5556
    s_lshr_b32 s7, s7, 13
    s_lshl_b32 s53, s7, 10
    s_add_u32 s7, s3, 8
    s_mul_i32 s7, s7, 0x5556
    s_lshr_b32 s7, s7, 13
    s_lshl_b32 s54, s7, 10
    s_add_u32 s7, s3, 12
    s_mul_i32 s7, s7, 0x5556
    s_lshr_b32 s7, s7, 13
    s_lshl_b32 s55, s7, 10
    s_add_u32 s56, s52, 1024
    s_add_u32 s57, s53, 1024
    s_add_u32 s58, s54, 1024
    s_add_u32 s59, s55, 1024
    s_add_u32 s7, s3, 0
    s_lshr_b32 s6, s7, 1
    s_lshl_b32 s6, s6, 3
    s_and_b32 s60, s7, 1
    s_mul_i32 s60, s60, 3
    s_add_u32 s6, s6, s60
    s_add_u32 s6, s6, 4
    s_add_u32 s7, s7, 32
    s_cmp_ge_u32 s7, 42
    s_cselect_b32 s6, s7, s6
    s_lshl_b32 s60, s6, 10
    s_add_u32 s7, s3, 4
    s_lshr_b32 s6, s7, 1
    s_lshl_b32 s6, s6, 3
    s_and_b32 s61, s7, 1
    s_mul_i32 s61, s61, 3
    s_add_u32 s6, s6, s61
    s_add_u32 s6, s6, 4
    s_add_u32 s7, s7, 32
    s_cmp_ge_u32 s7, 42
    s_cselect_b32 s6, s7, s6
    s_lshl_b32 s61, s6, 10
    s_add_u32 s7, s3, 8
    s_lshr_b32 s6, s7, 1
    s_lshl_b32 s6, s6, 3
    s_and_b32 s62, s7, 1
    s_mul_i32 s62, s62, 3
    s_add_u32 s6, s6, s62
    s_add_u32 s6, s6, 4
    s_add_u32 s7, s7, 32
    s_cmp_ge_u32 s7, 42
    s_cselect_b32 s6, s7, s6
    s_lshl_b32 s62, s6, 10
    s_lshl_b32 s6, s65, 16
    s_lshl_b32 s7, s3, 14
    s_add_u32 s6, s6, s7
    s_add_u32 s6, s6, 17825792
    v_add_u32 v12, s6, v4
    v_add_u32 v13, 0x10000, v12
    v_add_u32 v14, 0x20000, v12
    s_waitcnt vmcnt(26) lgkmcnt(0)
    s_barrier
    ds_read_b128 v[32:35], v26 offset:0
    ds_read_b128 v[36:39], v26 offset:16
    ds_read_b128 v[42:45], v26 offset:32
    ds_read_b128 v[46:49], v26 offset:48
    ds_read_b128 a[0:3], v4 offset:0
    ds_read_b128 a[4:7], v4 offset:1024
    ds_read_b128 a[8:11], v4 offset:2048
    ds_read_b128 a[12:15], v4 offset:3072
    ds_read_b128 a[16:19], v4 offset:4096
    ds_read_b128 a[20:23], v4 offset:5120
    s_waitcnt lgkmcnt(6)
    v_fma_mix_f32 v51, v128, v32, v42 op_sel:[0,0,0] op_sel_hi:[1,0,0]
    v_fma_mix_f32 v52, v128, v33, v43 op_sel:[1,0,0] op_sel_hi:[1,0,0]
    v_fma_mix_f32 v53, v129, v34, v44 op_sel:[0,0,0] op_sel_hi:[1,0,0]
    v_fma_mix_f32 v54, v129, v35, v45 op_sel:[1,0,0] op_sel_hi:[1,0,0]
    v_fma_mix_f32 v55, v130, v36, v46 op_sel:[0,0,0] op_sel_hi:[1,0,0]
    v_fma_mix_f32 v56, v130, v37, v47 op_sel:[1,0,0] op_sel_hi:[1,0,0]
    v_fma_mix_f32 v57, v131, v38, v48 op_sel:[0,0,0] op_sel_hi:[1,0,0]
    v_fma_mix_f32 v58, v131, v39, v49 op_sel:[1,0,0] op_sel_hi:[1,0,0]
    v_fma_mix_f32 v59, v132, v32, v42 op_sel:[0,0,0] op_sel_hi:[1,0,0]
    v_fma_mix_f32 v60, v132, v33, v43 op_sel:[1,0,0] op_sel_hi:[1,0,0]
    v_fma_mix_f32 v61, v133, v34, v44 op_sel:[0,0,0] op_sel_hi:[1,0,0]
    v_fma_mix_f32 v62, v133, v35, v45 op_sel:[1,0,0] op_sel_hi:[1,0,0]
    v_fma_mix_f32 v63, v134, v36, v46 op_sel:[0,0,0] op_sel_hi:[1,0,0]
    v_fma_mix_f32 v28, v134, v37, v47 op_sel:[1,0,0] op_sel_hi:[1,0,0]
    v_fma_mix_f32 v29, v135, v38, v48 op_sel:[0,0,0] op_sel_hi:[1,0,0]
    v_fma_mix_f32 v30, v135, v39, v49 op_sel:[1,0,0] op_sel_hi:[1,0,0]
    ds_read_b128 v[32:35], v26 offset:256
    ds_read_b128 v[36:39], v26 offset:272
    ds_read_b128 v[42:45], v26 offset:288
    ds_read_b128 v[46:49], v26 offset:304
    v_cvt_pk_bf16_f32 v128, v51, v52
    v_cvt_pk_bf16_f32 v129, v53, v54
    v_cvt_pk_bf16_f32 v130, v55, v56
    v_cvt_pk_bf16_f32 v131, v57, v58
    v_cvt_pk_bf16_f32 v132, v59, v60
    v_cvt_pk_bf16_f32 v133, v61, v62
    v_cvt_pk_bf16_f32 v134, v63, v28
    v_cvt_pk_bf16_f32 v135, v29, v30
    s_waitcnt lgkmcnt(4)
    v_mfma_f32_16x16x32_bf16 v[64:67], a[0:3], v[128:131], 0
    ds_read_b128 a[24:27], v4 offset:6144
    v_mfma_f32_16x16x32_bf16 v[88:91], a[0:3], v[132:135], 0
    ds_read_b128 a[28:31], v4 offset:7168
    buffer_load_dwordx4 v[168:171], v16, s[48:51], s17 offen
    buffer_load_dwordx4 v[172:175], v17, s[48:51], s17 offen
    v_mfma_f32_16x16x32_bf16 v[68:71], a[4:7], v[128:131], 0
    ds_read_b128 a[32:35], v4 offset:8192
    s_waitcnt vmcnt(26) lgkmcnt(3)
    v_fma_mix_f32 v51, v136, v32, v42 op_sel:[0,0,0] op_sel_hi:[1,0,0]
    v_fma_mix_f32 v52, v136, v33, v43 op_sel:[1,0,0] op_sel_hi:[1,0,0]
    v_fma_mix_f32 v53, v137, v34, v44 op_sel:[0,0,0] op_sel_hi:[1,0,0]
    v_fma_mix_f32 v54, v137, v35, v45 op_sel:[1,0,0] op_sel_hi:[1,0,0]
    v_mfma_f32_16x16x32_bf16 v[92:95], a[4:7], v[132:135], 0
    ds_read_b128 a[36:39], v4 offset:9216
    v_fma_mix_f32 v55, v138, v36, v46 op_sel:[0,0,0] op_sel_hi:[1,0,0]
    v_fma_mix_f32 v56, v138, v37, v47 op_sel:[1,0,0] op_sel_hi:[1,0,0]
    v_fma_mix_f32 v57, v139, v38, v48 op_sel:[0,0,0] op_sel_hi:[1,0,0]
    v_fma_mix_f32 v58, v139, v39, v49 op_sel:[1,0,0] op_sel_hi:[1,0,0]
    v_mfma_f32_16x16x32_bf16 v[72:75], a[8:11], v[128:131], 0
    ds_read_b128 a[40:43], v4 offset:10240
    v_fma_mix_f32 v59, v140, v32, v42 op_sel:[0,0,0] op_sel_hi:[1,0,0]
    v_fma_mix_f32 v60, v140, v33, v43 op_sel:[1,0,0] op_sel_hi:[1,0,0]
    v_fma_mix_f32 v61, v141, v34, v44 op_sel:[0,0,0] op_sel_hi:[1,0,0]
    v_fma_mix_f32 v62, v141, v35, v45 op_sel:[1,0,0] op_sel_hi:[1,0,0]
    s_add_u32 m0, s33, 49152
    s_nop 0
    buffer_load_dwordx4 v20, s[48:51], s30 offen lds
    v_mfma_f32_16x16x32_bf16 v[96:99], a[8:11], v[132:135], 0
    ds_read_b128 a[44:47], v4 offset:11264
    v_fma_mix_f32 v63, v142, v36, v46 op_sel:[0,0,0] op_sel_hi:[1,0,0]
    v_fma_mix_f32 v28, v142, v37, v47 op_sel:[1,0,0] op_sel_hi:[1,0,0]
    v_fma_mix_f32 v29, v143, v38, v48 op_sel:[0,0,0] op_sel_hi:[1,0,0]
    v_fma_mix_f32 v30, v143, v39, v49 op_sel:[1,0,0] op_sel_hi:[1,0,0]
    v_mfma_f32_16x16x32_bf16 v[76:79], a[12:15], v[128:131], 0
    ds_read_b128 v[32:35], v26 offset:512
    v_cvt_pk_bf16_f32 v136, v51, v52
    v_cvt_pk_bf16_f32 v137, v53, v54
    v_mfma_f32_16x16x32_bf16 v[100:103], a[12:15], v[132:135], 0
    ds_read_b128 v[36:39], v26 offset:528
    v_cvt_pk_bf16_f32 v138, v55, v56
    v_cvt_pk_bf16_f32 v139, v57, v58
    s_add_u32 m0, s33, 50176
    s_nop 0
    buffer_load_dwordx4 v21, s[48:51], s30 offen lds
    v_mfma_f32_16x16x32_bf16 v[80:83], v[128:131], a[16:19], 0
    ds_read_b128 v[42:45], v26 offset:544
    v_cvt_pk_bf16_f32 v140, v59, v60
    v_cvt_pk_bf16_f32 v141, v61, v62
    v_mfma_f32_16x16x32_bf16 v[104:107], v[132:135], a[16:19], 0
    ds_read_b128 v[46:49], v26 offset:560
    v_cvt_pk_bf16_f32 v142, v63, v28
    v_cvt_pk_bf16_f32 v143, v29, v30
    v_mfma_f32_16x16x32_bf16 v[84:87], v[128:131], a[20:23], 0
    v_mfma_f32_16x16x32_bf16 v[108:111], v[132:135], a[20:23], 0
    s_waitcnt lgkmcnt(4)
    v_mfma_f32_16x16x32_bf16 v[64:67], a[24:27], v[136:139], v[64:67]
    ds_read_b128 a[0:3], v4 offset:12288
    v_mfma_f32_16x16x32_bf16 v[88:91], a[24:27], v[140:143], v[88:91]
    ds_read_b128 a[4:7], v4 offset:13312
    buffer_load_dwordx4 v[176:179], v16, s[48:51], s18 offen
    buffer_load_dwordx4 v[180:183], v17, s[48:51], s18 offen
    v_mfma_f32_16x16x32_bf16 v[68:71], a[28:31], v[136:139], v[68:71]
    ds_read_b128 a[8:11], v4 offset:14336
    s_waitcnt vmcnt(22) lgkmcnt(3)
    v_fma_mix_f32 v51, v144, v32, v42 op_sel:[0,0,0] op_sel_hi:[1,0,0]
    v_fma_mix_f32 v52, v144, v33, v43 op_sel:[1,0,0] op_sel_hi:[1,0,0]
    v_fma_mix_f32 v53, v145, v34, v44 op_sel:[0,0,0] op_sel_hi:[1,0,0]
    v_fma_mix_f32 v54, v145, v35, v45 op_sel:[1,0,0] op_sel_hi:[1,0,0]
    v_mfma_f32_16x16x32_bf16 v[92:95], a[28:31], v[140:143], v[92:95]
    ds_read_b128 a[12:15], v4 offset:15360
    v_fma_mix_f32 v55, v146, v36, v46 op_sel:[0,0,0] op_sel_hi:[1,0,0]
    v_fma_mix_f32 v56, v146, v37, v47 op_sel:[1,0,0] op_sel_hi:[1,0,0]
    v_fma_mix_f32 v57, v147, v38, v48 op_sel:[0,0,0] op_sel_hi:[1,0,0]
    v_fma_mix_f32 v58, v147, v39, v49 op_sel:[1,0,0] op_sel_hi:[1,0,0]
    v_mfma_f32_16x16x32_bf16 v[72:75], a[32:35], v[136:139], v[72:75]
    ds_read_b128 a[16:19], v4 offset:16384
    v_fma_mix_f32 v59, v148, v32, v42 op_sel:[0,0,0] op_sel_hi:[1,0,0]
    v_fma_mix_f32 v60, v148, v33, v43 op_sel:[1,0,0] op_sel_hi:[1,0,0]
    v_fma_mix_f32 v61, v149, v34, v44 op_sel:[0,0,0] op_sel_hi:[1,0,0]
    v_fma_mix_f32 v62, v149, v35, v45 op_sel:[1,0,0] op_sel_hi:[1,0,0]
    s_add_u32 m0, s33, 51200
    s_nop 0
    buffer_load_dwordx4 v22, s[48:51], s30 offen lds
    v_mfma_f32_16x16x32_bf16 v[96:99], a[32:35], v[140:143], v[96:99]
    ds_read_b128 a[20:23], v4 offset:17408
    v_fma_mix_f32 v63, v150, v36, v46 op_sel:[0,0,0] op_sel_hi:[1,0,0]
    v_fma_mix_f32 v28, v150, v37, v47 op_sel:[1,0,0] op_sel_hi:[1,0,0]
    v_fma_mix_f32 v29, v151, v38, v48 op_sel:[0,0,0] op_sel_hi:[1,0,0]
    v_fma_mix_f32 v30, v151, v39, v49 op_sel:[1,0,0] op_sel_hi:[1,0,0]
    v_mfma_f32_16x16x32_bf16 v[76:79], a[36:39], v[136:139], v[76:79]
    ds_read_b128 v[32:35], v26 offset:768
    v_cvt_pk_bf16_f32 v144, v51, v52
    v_cvt_pk_bf16_f32 v145, v53, v54
    v_mfma_f32_16x16x32_bf16 v[100:103], a[36:39], v[140:143], v[100:103]
    ds_read_b128 v[36:39], v26 offset:784
    v_cvt_pk_bf16_f32 v146, v55, v56
    v_cvt_pk_bf16_f32 v147, v57, v58
    s_add_u32 m0, s33, 52224
    s_nop 0
    buffer_load_dwordx4 v23, s[48:51], s30 offen lds
    v_mfma_f32_16x16x32_bf16 v[80:83], v[136:139], a[40:43], v[80:83]
    ds_read_b128 v[42:45], v26 offset:800
    v_cvt_pk_bf16_f32 v148, v59, v60
    v_cvt_pk_bf16_f32 v149, v61, v62
    v_mfma_f32_16x16x32_bf16 v[104:107], v[140:143], a[40:43], v[104:107]
    ds_read_b128 v[46:49], v26 offset:816
    v_cvt_pk_bf16_f32 v150, v63, v28
    v_cvt_pk_bf16_f32 v151, v29, v30
    v_mfma_f32_16x16x32_bf16 v[84:87], v[136:139], a[44:47], v[84:87]
    v_mfma_f32_16x16x32_bf16 v[108:111], v[140:143], a[44:47], v[108:111]
    s_waitcnt lgkmcnt(4)
    v_mfma_f32_16x16x32_bf16 v[64:67], a[0:3], v[144:147], v[64:67]
    ds_read_b128 a[24:27], v4 offset:18432
    v_mfma_f32_16x16x32_bf16 v[88:91], a[0:3], v[148:151], v[88:91]
    ds_read_b128 a[28:31], v4 offset:19456
    buffer_load_dwordx4 v[184:187], v16, s[48:51], s19 offen
    buffer_load_dwordx4 v[188:191], v17, s[48:51], s19 offen
    v_mfma_f32_16x16x32_bf16 v[68:71], a[4:7], v[144:147], v[68:71]
    ds_read_b128 a[32:35], v4 offset:20480
    s_waitcnt vmcnt(24) lgkmcnt(3)
    v_fma_mix_f32 v51, v152, v32, v42 op_sel:[0,0,0] op_sel_hi:[1,0,0]
    v_fma_mix_f32 v52, v152, v33, v43 op_sel:[1,0,0] op_sel_hi:[1,0,0]
    v_fma_mix_f32 v53, v153, v34, v44 op_sel:[0,0,0] op_sel_hi:[1,0,0]
    v_fma_mix_f32 v54, v153, v35, v45 op_sel:[1,0,0] op_sel_hi:[1,0,0]
    v_mfma_f32_16x16x32_bf16 v[92:95], a[4:7], v[148:151], v[92:95]
    ds_read_b128 a[36:39], v4 offset:21504
    v_fma_mix_f32 v55, v154, v36, v46 op_sel:[0,0,0] op_sel_hi:[1,0,0]
    v_fma_mix_f32 v56, v154, v37, v47 op_sel:[1,0,0] op_sel_hi:[1,0,0]
    v_fma_mix_f32 v57, v155, v38, v48 op_sel:[0,0,0] op_sel_hi:[1,0,0]
    v_fma_mix_f32 v58, v155, v39, v49 op_sel:[1,0,0] op_sel_hi:[1,0,0]
    v_mfma_f32_16x16x32_bf16 v[72:75], a[8:11], v[144:147], v[72:75]
    ds_read_b128 a[40:43], v4 offset:22528
    v_fma_mix_f32 v59, v156, v32, v42 op_sel:[0,0,0] op_sel_hi:[1,0,0]
    v_fma_mix_f32 v60, v156, v33, v43 op_sel:[1,0,0] op_sel_hi:[1,0,0]
    v_fma_mix_f32 v61, v157, v34, v44 op_sel:[0,0,0] op_sel_hi:[1,0,0]
    v_fma_mix_f32 v62, v157, v35, v45 op_sel:[1,0,0] op_sel_hi:[1,0,0]
    s_add_u32 m0, s33, 53248
    s_nop 0
    buffer_load_dwordx4 v24, s[48:51], s30 offen lds
    v_mfma_f32_16x16x32_bf16 v[96:99], a[8:11], v[148:151], v[96:99]
    ds_read_b128 a[44:47], v4 offset:23552
    v_fma_mix_f32 v63, v158, v36, v46 op_sel:[0,0,0] op_sel_hi:[1,0,0]
    v_fma_mix_f32 v28, v158, v37, v47 op_sel:[1,0,0] op_sel_hi:[1,0,0]
    v_fma_mix_f32 v29, v159, v38, v48 op_sel:[0,0,0] op_sel_hi:[1,0,0]
    v_fma_mix_f32 v30, v159, v39, v49 op_sel:[1,0,0] op_sel_hi:[1,0,0]
    v_mfma_f32_16x16x32_bf16 v[76:79], a[12:15], v[144:147], v[76:79]
    ds_read_b128 v[32:35], v26 offset:1024
    v_cvt_pk_bf16_f32 v152, v51, v52
    v_cvt_pk_bf16_f32 v153, v53, v54
    v_mfma_f32_16x16x32_bf16 v[100:103], a[12:15], v[148:151], v[100:103]
    ds_read_b128 v[36:39], v26 offset:1040
    v_cvt_pk_bf16_f32 v154, v55, v56
    v_cvt_pk_bf16_f32 v155, v57, v58
    s_add_u32 m0, s33, 54272
    s_nop 0
    buffer_load_dwordx4 v25, s[48:51], s30 offen lds
    v_mfma_f32_16x16x32_bf16 v[80:83], v[144:147], a[16:19], v[80:83]
    ds_read_b128 v[42:45], v26 offset:1056
    v_cvt_pk_bf16_f32 v156, v59, v60
    v_cvt_pk_bf16_f32 v157, v61, v62
    v_mfma_f32_16x16x32_bf16 v[104:107], v[148:151], a[16:19], v[104:107]
    ds_read_b128 v[46:49], v26 offset:1072
    v_cvt_pk_bf16_f32 v158, v63, v28
    v_cvt_pk_bf16_f32 v159, v29, v30
    v_mfma_f32_16x16x32_bf16 v[84:87], v[144:147], a[20:23], v[84:87]
    v_mfma_f32_16x16x32_bf16 v[108:111], v[148:151], a[20:23], v[108:111]
    s_waitcnt vmcnt(30)
    s_barrier
    s_waitcnt lgkmcnt(4)
    v_mfma_f32_16x16x32_bf16 v[64:67], a[24:27], v[152:155], v[64:67]
    ds_read_b128 a[0:3], v4 offset:24576
    v_mfma_f32_16x16x32_bf16 v[88:91], a[24:27], v[156:159], v[88:91]
    ds_read_b128 a[4:7], v4 offset:25600
    buffer_load_dwordx4 v[192:195], v16, s[48:51], s20 offen
    buffer_load_dwordx4 v[196:199], v17, s[48:51], s20 offen
    v_mfma_f32_16x16x32_bf16 v[68:71], a[28:31], v[152:155], v[68:71]
    ds_read_b128 a[8:11], v4 offset:26624
    s_waitcnt vmcnt(26) lgkmcnt(3)
    v_fma_mix_f32 v51, v160, v32, v42 op_sel:[0,0,0] op_sel_hi:[1,0,0]
    v_fma_mix_f32 v52, v160, v33, v43 op_sel:[1,0,0] op_sel_hi:[1,0,0]
    v_fma_mix_f32 v53, v161, v34, v44 op_sel:[0,0,0] op_sel_hi:[1,0,0]
    v_fma_mix_f32 v54, v161, v35, v45 op_sel:[1,0,0] op_sel_hi:[1,0,0]
    v_mfma_f32_16x16x32_bf16 v[92:95], a[28:31], v[156:159], v[92:95]
    ds_read_b128 a[12:15], v4 offset:27648
    v_fma_mix_f32 v55, v162, v36, v46 op_sel:[0,0,0] op_sel_hi:[1,0,0]
    v_fma_mix_f32 v56, v162, v37, v47 op_sel:[1,0,0] op_sel_hi:[1,0,0]
    v_fma_mix_f32 v57, v163, v38, v48 op_sel:[0,0,0] op_sel_hi:[1,0,0]
    v_fma_mix_f32 v58, v163, v39, v49 op_sel:[1,0,0] op_sel_hi:[1,0,0]
    v_mfma_f32_16x16x32_bf16 v[72:75], a[32:35], v[152:155], v[72:75]
    ds_read_b128 a[16:19], v4 offset:28672
    v_fma_mix_f32 v59, v164, v32, v42 op_sel:[0,0,0] op_sel_hi:[1,0,0]
    v_fma_mix_f32 v60, v164, v33, v43 op_sel:[1,0,0] op_sel_hi:[1,0,0]
    v_fma_mix_f32 v61, v165, v34, v44 op_sel:[0,0,0] op_sel_hi:[1,0,0]
    v_fma_mix_f32 v62, v165, v35, v45 op_sel:[1,0,0] op_sel_hi:[1,0,0]
    v_mfma_f32_16x16x32_bf16 v[96:99], a[32:35], v[156:159], v[96:99]
    ds_read_b128 a[20:23], v4 offset:29696
    v_fma_mix_f32 v63, v166, v36, v46 op_sel:[0,0,0] op_sel_hi:[1,0,0]
    v_fma_mix_f32 v28, v166, v37, v47 op_sel:[1,0,0] op_sel_hi:[1,0,0]
    v_fma_mix_f32 v29, v167, v38, v48 op_sel:[0,0,0] op_sel_hi:[1,0,0]
    v_fma_mix_f32 v30, v167, v39, v49 op_sel:[1,0,0] op_sel_hi:[1,0,0]
    v_mfma_f32_16x16x32_bf16 v[76:79], a[36:39], v[152:155], v[76:79]
    ds_read_b128 v[32:35], v26 offset:1280
    v_cvt_pk_bf16_f32 v160, v51, v52
    v_cvt_pk_bf16_f32 v161, v53, v54
    v_mfma_f32_16x16x32_bf16 v[100:103], a[36:39], v[156:159], v[100:103]
    ds_read_b128 v[36:39], v26 offset:1296
    v_cvt_pk_bf16_f32 v162, v55, v56
    v_cvt_pk_bf16_f32 v163, v57, v58
    v_mfma_f32_16x16x32_bf16 v[80:83], v[152:155], a[40:43], v[80:83]
    ds_read_b128 v[42:45], v26 offset:1312
    v_cvt_pk_bf16_f32 v164, v59, v60
    v_cvt_pk_bf16_f32 v165, v61, v62
    v_mfma_f32_16x16x32_bf16 v[104:107], v[156:159], a[40:43], v[104:107]
    ds_read_b128 v[46:49], v26 offset:1328
    v_cvt_pk_bf16_f32 v166, v63, v28
    v_cvt_pk_bf16_f32 v167, v29, v30
    v_mfma_f32_16x16x32_bf16 v[84:87], v[152:155], a[44:47], v[84:87]
    v_mfma_f32_16x16x32_bf16 v[108:111], v[156:159], a[44:47], v[108:111]
    s_waitcnt lgkmcnt(4)
    v_mfma_f32_16x16x32_bf16 v[64:67], a[0:3], v[160:163], v[64:67]
    ds_read_b128 a[24:27], v4 offset:30720
    v_mfma_f32_16x16x32_bf16 v[88:91], a[0:3], v[164:167], v[88:91]
    ds_read_b128 a[28:31], v4 offset:31744
    buffer_load_dwordx4 v[200:203], v16, s[48:51], s21 offen
    buffer_load_dwordx4 v[204:207], v17, s[48:51], s21 offen
    v_mfma_f32_16x16x32_bf16 v[68:71], a[4:7], v[160:163], v[68:71]
    ds_read_b128 a[32:35], v4 offset:32768
    s_waitcnt vmcnt(14) lgkmcnt(3)
    v_fma_mix_f32 v51, v168, v32, v42 op_sel:[0,0,0] op_sel_hi:[1,0,0]
    v_fma_mix_f32 v52, v168, v33, v43 op_sel:[1,0,0] op_sel_hi:[1,0,0]
    v_fma_mix_f32 v53, v169, v34, v44 op_sel:[0,0,0] op_sel_hi:[1,0,0]
    v_fma_mix_f32 v54, v169, v35, v45 op_sel:[1,0,0] op_sel_hi:[1,0,0]
    v_mfma_f32_16x16x32_bf16 v[92:95], a[4:7], v[164:167], v[92:95]
    ds_read_b128 a[36:39], v4 offset:33792
    v_fma_mix_f32 v55, v170, v36, v46 op_sel:[0,0,0] op_sel_hi:[1,0,0]
    v_fma_mix_f32 v56, v170, v37, v47 op_sel:[1,0,0] op_sel_hi:[1,0,0]
    v_fma_mix_f32 v57, v171, v38, v48 op_sel:[0,0,0] op_sel_hi:[1,0,0]
    v_fma_mix_f32 v58, v171, v39, v49 op_sel:[1,0,0] op_sel_hi:[1,0,0]
    v_mfma_f32_16x16x32_bf16 v[72:75], a[8:11], v[160:163], v[72:75]
    ds_read_b128 a[40:43], v4 offset:34816
    v_fma_mix_f32 v59, v172, v32, v42 op_sel:[0,0,0] op_sel_hi:[1,0,0]
    v_fma_mix_f32 v60, v172, v33, v43 op_sel:[1,0,0] op_sel_hi:[1,0,0]
    v_fma_mix_f32 v61, v173, v34, v44 op_sel:[0,0,0] op_sel_hi:[1,0,0]
    v_fma_mix_f32 v62, v173, v35, v45 op_sel:[1,0,0] op_sel_hi:[1,0,0]
    s_add_u32 m0, s33, 73728
    s_nop 0
    buffer_load_dwordx4 v20, s[48:51], s31 offen lds
    v_mfma_f32_16x16x32_bf16 v[96:99], a[8:11], v[164:167], v[96:99]
    ds_read_b128 a[44:47], v4 offset:35840
    v_fma_mix_f32 v63, v174, v36, v46 op_sel:[0,0,0] op_sel_hi:[1,0,0]
    v_fma_mix_f32 v28, v174, v37, v47 op_sel:[1,0,0] op_sel_hi:[1,0,0]
    v_fma_mix_f32 v29, v175, v38, v48 op_sel:[0,0,0] op_sel_hi:[1,0,0]
    v_fma_mix_f32 v30, v175, v39, v49 op_sel:[1,0,0] op_sel_hi:[1,0,0]
    v_mfma_f32_16x16x32_bf16 v[76:79], a[12:15], v[160:163], v[76:79]
    ds_read_b128 v[32:35], v26 offset:1536
    v_cvt_pk_bf16_f32 v168, v51, v52
    v_cvt_pk_bf16_f32 v169, v53, v54
    v_mfma_f32_16x16x32_bf16 v[100:103], a[12:15], v[164:167], v[100:103]
    ds_read_b128 v[36:39], v26 offset:1552
    v_cvt_pk_bf16_f32 v170, v55, v56
    v_cvt_pk_bf16_f32 v171, v57, v58
    s_add_u32 m0, s33, 74752
    s_nop 0
    buffer_load_dwordx4 v21, s[48:51], s31 offen lds
    v_mfma_f32_16x16x32_bf16 v[80:83], v[160:163], a[16:19], v[80:83]
    ds_read_b128 v[42:45], v26 offset:1568
    v_cvt_pk_bf16_f32 v172, v59, v60
    v_cvt_pk_bf16_f32 v173, v61, v62
    v_mfma_f32_16x16x32_bf16 v[104:107], v[164:167], a[16:19], v[104:107]
    ds_read_b128 v[46:49], v26 offset:1584
    v_cvt_pk_bf16_f32 v174, v63, v28
    v_cvt_pk_bf16_f32 v175, v29, v30
    v_mfma_f32_16x16x32_bf16 v[84:87], v[160:163], a[20:23], v[84:87]
    v_mfma_f32_16x16x32_bf16 v[108:111], v[164:167], a[20:23], v[108:111]
    s_waitcnt lgkmcnt(4)
    v_mfma_f32_16x16x32_bf16 v[64:67], a[24:27], v[168:171], v[64:67]
    ds_read_b128 a[0:3], v4 offset:36864
    v_mfma_f32_16x16x32_bf16 v[88:91], a[24:27], v[172:175], v[88:91]
    ds_read_b128 a[4:7], v4 offset:37888
    buffer_load_dwordx4 v[208:211], v16, s[48:51], s22 offen
    buffer_load_dwordx4 v[212:215], v17, s[48:51], s22 offen
    v_mfma_f32_16x16x32_bf16 v[68:71], a[28:31], v[168:171], v[68:71]
    ds_read_b128 a[8:11], v4 offset:38912
    s_waitcnt vmcnt(14) lgkmcnt(3)
    v_fma_mix_f32 v51, v176, v32, v42 op_sel:[0,0,0] op_sel_hi:[1,0,0]
    v_fma_mix_f32 v52, v176, v33, v43 op_sel:[1,0,0] op_sel_hi:[1,0,0]
    v_fma_mix_f32 v53, v177, v34, v44 op_sel:[0,0,0] op_sel_hi:[1,0,0]
    v_fma_mix_f32 v54, v177, v35, v45 op_sel:[1,0,0] op_sel_hi:[1,0,0]
    v_mfma_f32_16x16x32_bf16 v[92:95], a[28:31], v[172:175], v[92:95]
    ds_read_b128 a[12:15], v4 offset:39936
    v_fma_mix_f32 v55, v178, v36, v46 op_sel:[0,0,0] op_sel_hi:[1,0,0]
    v_fma_mix_f32 v56, v178, v37, v47 op_sel:[1,0,0] op_sel_hi:[1,0,0]
    v_fma_mix_f32 v57, v179, v38, v48 op_sel:[0,0,0] op_sel_hi:[1,0,0]
    v_fma_mix_f32 v58, v179, v39, v49 op_sel:[1,0,0] op_sel_hi:[1,0,0]
    v_mfma_f32_16x16x32_bf16 v[72:75], a[32:35], v[168:171], v[72:75]
    ds_read_b128 a[16:19], v4 offset:40960
    v_fma_mix_f32 v59, v180, v32, v42 op_sel:[0,0,0] op_sel_hi:[1,0,0]
    v_fma_mix_f32 v60, v180, v33, v43 op_sel:[1,0,0] op_sel_hi:[1,0,0]
    v_fma_mix_f32 v61, v181, v34, v44 op_sel:[0,0,0] op_sel_hi:[1,0,0]
    v_fma_mix_f32 v62, v181, v35, v45 op_sel:[1,0,0] op_sel_hi:[1,0,0]
    s_add_u32 m0, s33, 75776
    s_nop 0
    buffer_load_dwordx4 v22, s[48:51], s31 offen lds
    v_mfma_f32_16x16x32_bf16 v[96:99], a[32:35], v[172:175], v[96:99]
    ds_read_b128 a[20:23], v4 offset:41984
    v_fma_mix_f32 v63, v182, v36, v46 op_sel:[0,0,0] op_sel_hi:[1,0,0]
    v_fma_mix_f32 v28, v182, v37, v47 op_sel:[1,0,0] op_sel_hi:[1,0,0]
    v_fma_mix_f32 v29, v183, v38, v48 op_sel:[0,0,0] op_sel_hi:[1,0,0]
    v_fma_mix_f32 v30, v183, v39, v49 op_sel:[1,0,0] op_sel_hi:[1,0,0]
    v_mfma_f32_16x16x32_bf16 v[76:79], a[36:39], v[168:171], v[76:79]
    ds_read_b128 v[32:35], v26 offset:1792
    v_cvt_pk_bf16_f32 v176, v51, v52
    v_cvt_pk_bf16_f32 v177, v53, v54
    v_mfma_f32_16x16x32_bf16 v[100:103], a[36:39], v[172:175], v[100:103]
    ds_read_b128 v[36:39], v26 offset:1808
    v_cvt_pk_bf16_f32 v178, v55, v56
    v_cvt_pk_bf16_f32 v179, v57, v58
    s_add_u32 m0, s33, 76800
    s_nop 0
    buffer_load_dwordx4 v23, s[48:51], s31 offen lds
    v_mfma_f32_16x16x32_bf16 v[80:83], v[168:171], a[40:43], v[80:83]
    ds_read_b128 v[42:45], v26 offset:1824
    v_cvt_pk_bf16_f32 v180, v59, v60
    v_cvt_pk_bf16_f32 v181, v61, v62
    v_mfma_f32_16x16x32_bf16 v[104:107], v[172:175], a[40:43], v[104:107]
    ds_read_b128 v[46:49], v26 offset:1840
    v_cvt_pk_bf16_f32 v182, v63, v28
    v_cvt_pk_bf16_f32 v183, v29, v30
    v_mfma_f32_16x16x32_bf16 v[84:87], v[168:171], a[44:47], v[84:87]
    v_mfma_f32_16x16x32_bf16 v[108:111], v[172:175], a[44:47], v[108:111]
    s_waitcnt lgkmcnt(4)
    v_mfma_f32_16x16x32_bf16 v[64:67], a[0:3], v[176:179], v[64:67]
    ds_read_b128 a[24:27], v4 offset:43008
    v_mfma_f32_16x16x32_bf16 v[88:91], a[0:3], v[180:183], v[88:91]
    ds_read_b128 a[28:31], v4 offset:44032
    buffer_load_dwordx4 v[216:219], v16, s[48:51], s23 offen
    buffer_load_dwordx4 v[220:223], v17, s[48:51], s23 offen
    v_mfma_f32_16x16x32_bf16 v[68:71], a[4:7], v[176:179], v[68:71]
    ds_read_b128 a[32:35], v4 offset:45056
    s_waitcnt vmcnt(14) lgkmcnt(3)
    v_fma_mix_f32 v51, v184, v32, v42 op_sel:[0,0,0] op_sel_hi:[1,0,0]
    v_fma_mix_f32 v52, v184, v33, v43 op_sel:[1,0,0] op_sel_hi:[1,0,0]
    v_fma_mix_f32 v53, v185, v34, v44 op_sel:[0,0,0] op_sel_hi:[1,0,0]
    v_fma_mix_f32 v54, v185, v35, v45 op_sel:[1,0,0] op_sel_hi:[1,0,0]
    v_mfma_f32_16x16x32_bf16 v[92:95], a[4:7], v[180:183], v[92:95]
    ds_read_b128 a[36:39], v4 offset:46080
    v_fma_mix_f32 v55, v186, v36, v46 op_sel:[0,0,0] op_sel_hi:[1,0,0]
    v_fma_mix_f32 v56, v186, v37, v47 op_sel:[1,0,0] op_sel_hi:[1,0,0]
    v_fma_mix_f32 v57, v187, v38, v48 op_sel:[0,0,0] op_sel_hi:[1,0,0]
    v_fma_mix_f32 v58, v187, v39, v49 op_sel:[1,0,0] op_sel_hi:[1,0,0]
    v_mfma_f32_16x16x32_bf16 v[72:75], a[8:11], v[176:179], v[72:75]
    ds_read_b128 a[40:43], v4 offset:47104
    v_fma_mix_f32 v59, v188, v32, v42 op_sel:[0,0,0] op_sel_hi:[1,0,0]
    v_fma_mix_f32 v60, v188, v33, v43 op_sel:[1,0,0] op_sel_hi:[1,0,0]
    v_fma_mix_f32 v61, v189, v34, v44 op_sel:[0,0,0] op_sel_hi:[1,0,0]
    v_fma_mix_f32 v62, v189, v35, v45 op_sel:[1,0,0] op_sel_hi:[1,0,0]
    s_add_u32 m0, s33, 77824
    s_nop 0
    buffer_load_dwordx4 v24, s[48:51], s31 offen lds
    v_mfma_f32_16x16x32_bf16 v[96:99], a[8:11], v[180:183], v[96:99]
    ds_read_b128 a[44:47], v4 offset:48128
    v_fma_mix_f32 v63, v190, v36, v46 op_sel:[0,0,0] op_sel_hi:[1,0,0]
    v_fma_mix_f32 v28, v190, v37, v47 op_sel:[1,0,0] op_sel_hi:[1,0,0]
    v_fma_mix_f32 v29, v191, v38, v48 op_sel:[0,0,0] op_sel_hi:[1,0,0]
    v_fma_mix_f32 v30, v191, v39, v49 op_sel:[1,0,0] op_sel_hi:[1,0,0]
    v_mfma_f32_16x16x32_bf16 v[76:79], a[12:15], v[176:179], v[76:79]
    ds_read_b128 v[32:35], v26 offset:2048
    v_cvt_pk_bf16_f32 v184, v51, v52
    v_cvt_pk_bf16_f32 v185, v53, v54
    v_mfma_f32_16x16x32_bf16 v[100:103], a[12:15], v[180:183], v[100:103]
    ds_read_b128 v[36:39], v26 offset:2064
    v_cvt_pk_bf16_f32 v186, v55, v56
    v_cvt_pk_bf16_f32 v187, v57, v58
    s_add_u32 m0, s33, 78848
    s_nop 0
    buffer_load_dwordx4 v25, s[48:51], s31 offen lds
    v_mfma_f32_16x16x32_bf16 v[80:83], v[176:179], a[16:19], v[80:83]
    ds_read_b128 v[42:45], v26 offset:2080
    v_cvt_pk_bf16_f32 v188, v59, v60
    v_cvt_pk_bf16_f32 v189, v61, v62
    v_mfma_f32_16x16x32_bf16 v[104:107], v[180:183], a[16:19], v[104:107]
    ds_read_b128 v[46:49], v26 offset:2096
    v_cvt_pk_bf16_f32 v190, v63, v28
    v_cvt_pk_bf16_f32 v191, v29, v30
    v_mfma_f32_16x16x32_bf16 v[84:87], v[176:179], a[20:23], v[84:87]
    v_mfma_f32_16x16x32_bf16 v[108:111], v[180:183], a[20:23], v[108:111]
    s_waitcnt vmcnt(14)
    s_barrier
    v_and_b32 v129, 3, v2
    s_cmp_eq_u32 s3, 0
    s_nop 3
    s_cbranch_scc1 RP_13
    v_accvgpr_read_b32 v140, a152
    v_accvgpr_read_b32 v141, a153
    v_accvgpr_read_b32 v142, a154
    v_accvgpr_read_b32 v143, a155
    v_accvgpr_read_b32 v144, a156
    v_accvgpr_read_b32 v145, a157
    v_accvgpr_read_b32 v146, a158
    v_accvgpr_read_b32 v147, a159
    v_accvgpr_read_b32 v148, a160
    v_accvgpr_read_b32 v149, a161
    v_accvgpr_read_b32 v150, a162
    v_accvgpr_read_b32 v151, a163
    v_accvgpr_read_b32 v152, a164
    v_accvgpr_read_b32 v153, a165
    v_accvgpr_read_b32 v154, a166
    v_accvgpr_read_b32 v155, a167
    v_accvgpr_read_b32 v172, a144
    v_accvgpr_read_b32 v173, a145
    v_accvgpr_read_b32 v174, a146
    v_accvgpr_read_b32 v175, a147
    v_accvgpr_read_b32 v176, a148
    v_accvgpr_read_b32 v177, a149
    v_accvgpr_read_b32 v178, a150
    v_accvgpr_read_b32 v179, a151
    v_add_f32 v172, v172, v173
    v_add_f32 v174, v174, v175
    v_add_f32 v176, v176, v177
    v_add_f32 v178, v178, v179
    v_add_f32 v172, v172, v174
    v_add_f32 v176, v176, v178
    v_cvt_pk_bf16_f32 v172, v172, v172
    v_and_b32 v172, 0xffff0000, v172
    v_cvt_pk_bf16_f32 v176, v176, v176
    v_and_b32 v176, 0xffff0000, v176
    v_cmp_lt_u32 vcc, 31, v1
    s_nop 1
    v_cndmask_b32 v173, 0, 1.0, vcc
    v_add_f32 v172, v172, v173
    s_cmp_eq_u32 s3, 3
    s_cselect_b32 s6, 1.0, 0
    v_add_f32 v176, s6, v176
    v_cvt_pk_bf16_f32 v176, v176, v176
    v_and_b32 v176, 0xffff0000, v176
    v_cvt_pk_bf16_f32 v172, v172, v172
    s_lshl_b32 s6, s3, 7
    s_add_u32 s6, s6, 163328
    v_lshlrev_b32 v173, 1, v1
    v_add_u32 v173, s6, v173
    ds_write_b16 v173, v172
    s_lshl_b32 s7, s3, 8
    s_add_u32 s7, s7, 161280
    v_lshlrev_b32 v174, 2, v1
    v_add_u32 v174, s7, v174
    ds_write_b32 v174, v176
    v_lshlrev_b32 v173, 4, v3
    v_add_u32 v173, s6, v173
    s_waitcnt lgkmcnt(0)
    ds_read_b128 v[156:159], v173
    ds_read_b128 v[160:163], v173 offset:64
    v_lshrrev_b32 v130, 2, v2
    v_lshl_add_u32 v130, v130, 3, v129
    v_lshlrev_b32 v130, 2, v130
    v_lshrrev_b32 v131, 1, v3
    s_movk_i32 s7, 384
    v_mul_lo_u32 v131, v131, s7
    v_add_u32 v130, v130, v131
    s_lshl_b32 s34, s5, 4
    s_add_u32 s34, s34, s4
    s_mul_i32 s34, s34, 1536
    s_lshl_b32 s6, s3, 7
    s_add_u32 s34, s34, s6
    s_add_u32 s34, s34, 20971392
    v_mov_b32 v164, 0
    v_mov_b32 v165, 0
    v_mov_b32 v166, 0
    v_mov_b32 v167, 0
    v_mov_b32 v168, 0
    v_mov_b32 v169, 0
    v_mov_b32 v170, 0
    v_mov_b32 v171, 0
    s_waitcnt lgkmcnt(0)
    v_dot2_f32_bf16 v164, v140, v160, v164
    v_dot2_f32_bf16 v165, v140, v156, v165
    v_dot2_f32_bf16 v166, v144, v160, v166
    v_dot2_f32_bf16 v167, v144, v156, v167
    v_dot2_f32_bf16 v168, v148, v160, v168
    v_dot2_f32_bf16 v169, v148, v156, v169
    v_dot2_f32_bf16 v170, v152, v160, v170
    v_dot2_f32_bf16 v171, v152, v156, v171
    v_dot2_f32_bf16 v164, v141, v161, v164
    v_dot2_f32_bf16 v165, v141, v157, v165
    v_dot2_f32_bf16 v166, v145, v161, v166
    v_dot2_f32_bf16 v167, v145, v157, v167
    v_dot2_f32_bf16 v168, v149, v161, v168
    v_dot2_f32_bf16 v169, v149, v157, v169
    v_dot2_f32_bf16 v170, v153, v161, v170
    v_dot2_f32_bf16 v171, v153, v157, v171
    v_dot2_f32_bf16 v164, v142, v162, v164
    v_dot2_f32_bf16 v165, v142, v158, v165
    v_dot2_f32_bf16 v166, v146, v162, v166
    v_dot2_f32_bf16 v167, v146, v158, v167
    v_dot2_f32_bf16 v168, v150, v162, v168
    v_dot2_f32_bf16 v169, v150, v158, v169
    v_dot2_f32_bf16 v170, v154, v162, v170
    v_dot2_f32_bf16 v171, v154, v158, v171
    v_dot2_f32_bf16 v164, v143, v163, v164
    v_dot2_f32_bf16 v165, v143, v159, v165
    v_dot2_f32_bf16 v166, v147, v163, v166
    v_dot2_f32_bf16 v167, v147, v159, v167
    v_dot2_f32_bf16 v168, v151, v163, v168
    v_dot2_f32_bf16 v169, v151, v159, v169
    v_dot2_f32_bf16 v170, v155, v163, v170
    v_dot2_f32_bf16 v171, v155, v159, v171
    v_permlane32_swap_b32 v164, v165
    v_permlane32_swap_b32 v166, v167
    v_permlane32_swap_b32 v168, v169
    v_permlane32_swap_b32 v170, v171
    v_add_f32 v164, v164, v165
    v_add_f32 v166, v166, v167
    v_add_f32 v168, v168, v169
    v_add_f32 v170, v170, v171
    v_mov_b32 v165, v164
    v_mov_b32 v167, v166
    v_mov_b32 v169, v168
    v_mov_b32 v171, v170
    v_permlane16_swap_b32 v164, v165
    v_permlane16_swap_b32 v166, v167
    v_permlane16_swap_b32 v168, v169
    v_permlane16_swap_b32 v170, v171
    v_add_f32 v164, v164, v165
    v_add_f32 v166, v166, v167
    v_add_f32 v168, v168, v169
    v_add_f32 v170, v170, v171
    buffer_store_dword v164, v130, s[48:51], s34 offen offset:0 sc1
    buffer_store_dword v166, v130, s[48:51], s34 offen offset:16 sc1
    buffer_store_dword v168, v130, s[48:51], s34 offen offset:768 sc1
    buffer_store_dword v170, v130, s[48:51], s34 offen offset:784 sc1
    s_nop 0
    s_branch RP_14
    s_nop 1
RP_13:
    s_mov_b64 exec, 1
    buffer_load_dword a136, v4, s[48:51], 0 offen
    buffer_load_dword a137, v4, s[48:51], 0 offen
    buffer_load_dword a138, v4, s[48:51], 0 offen
    buffer_load_dword a139, v4, s[48:51], 0 offen
    s_mov_b64 exec, -1
    s_waitcnt lgkmcnt(0)
    s_nop 1
RP_14:
    s_waitcnt lgkmcnt(4)
    v_mfma_f32_16x16x32_bf16 v[64:67], a[24:27], v[184:187], v[64:67]
    ds_read_b128 a[0:3], v4 offset:49152
    v_mfma_f32_16x16x32_bf16 v[88:91], a[24:27], v[188:191], v[88:91]
    ds_read_b128 a[4:7], v4 offset:50176
    buffer_load_dwordx4 v[224:227], v16, s[48:51], s24 offen
    buffer_load_dwordx4 v[228:231], v17, s[48:51], s24 offen
    v_mfma_f32_16x16x32_bf16 v[68:71], a[28:31], v[184:187], v[68:71]
    ds_read_b128 a[8:11], v4 offset:51200
    s_waitcnt vmcnt(18) lgkmcnt(3)
    v_fma_mix_f32 v51, v192, v32, v42 op_sel:[0,0,0] op_sel_hi:[1,0,0]
    v_fma_mix_f32 v52, v192, v33, v43 op_sel:[1,0,0] op_sel_hi:[1,0,0]
    v_fma_mix_f32 v53, v193, v34, v44 op_sel:[0,0,0] op_sel_hi:[1,0,0]
    v_fma_mix_f32 v54, v193, v35, v45 op_sel:[1,0,0] op_sel_hi:[1,0,0]
    v_mfma_f32_16x16x32_bf16 v[92:95], a[28:31], v[188:191], v[92:95]
    ds_read_b128 a[12:15], v4 offset:52224
    v_fma_mix_f32 v55, v194, v36, v46 op_sel:[0,0,0] op_sel_hi:[1,0,0]
    v_fma_mix_f32 v56, v194, v37, v47 op_sel:[1,0,0] op_sel_hi:[1,0,0]
    v_fma_mix_f32 v57, v195, v38, v48 op_sel:[0,0,0] op_sel_hi:[1,0,0]
    v_fma_mix_f32 v58, v195, v39, v49 op_sel:[1,0,0] op_sel_hi:[1,0,0]
    v_mfma_f32_16x16x32_bf16 v[72:75], a[32:35], v[184:187], v[72:75]
    ds_read_b128 a[16:19], v4 offset:53248
    v_fma_mix_f32 v59, v196, v32, v42 op_sel:[0,0,0] op_sel_hi:[1,0,0]
    v_fma_mix_f32 v60, v196, v33, v43 op_sel:[1,0,0] op_sel_hi:[1,0,0]
    v_fma_mix_f32 v61, v197, v34, v44 op_sel:[0,0,0] op_sel_hi:[1,0,0]
    v_fma_mix_f32 v62, v197, v35, v45 op_sel:[1,0,0] op_sel_hi:[1,0,0]
    v_mfma_f32_16x16x32_bf16 v[96:99], a[32:35], v[188:191], v[96:99]
    ds_read_b128 a[20:23], v4 offset:54272
    v_fma_mix_f32 v63, v198, v36, v46 op_sel:[0,0,0] op_sel_hi:[1,0,0]
    v_fma_mix_f32 v28, v198, v37, v47 op_sel:[1,0,0] op_sel_hi:[1,0,0]
    v_fma_mix_f32 v29, v199, v38, v48 op_sel:[0,0,0] op_sel_hi:[1,0,0]
    v_fma_mix_f32 v30, v199, v39, v49 op_sel:[1,0,0] op_sel_hi:[1,0,0]
    v_mfma_f32_16x16x32_bf16 v[76:79], a[36:39], v[184:187], v[76:79]
    ds_read_b128 v[32:35], v26 offset:2304
    v_cvt_pk_bf16_f32 v192, v51, v52
    v_cvt_pk_bf16_f32 v193, v53, v54
    v_mfma_f32_16x16x32_bf16 v[100:103], a[36:39], v[188:191], v[100:103]
    ds_read_b128 v[36:39], v26 offset:2320
    v_cvt_pk_bf16_f32 v194, v55, v56
    v_cvt_pk_bf16_f32 v195, v57, v58
    v_mfma_f32_16x16x32_bf16 v[80:83], v[184:187], a[40:43], v[80:83]
    ds_read_b128 v[42:45], v26 offset:2336
    v_cvt_pk_bf16_f32 v196, v59, v60
    v_cvt_pk_bf16_f32 v197, v61, v62
    v_mfma_f32_16x16x32_bf16 v[104:107], v[188:191], a[40:43], v[104:107]
    ds_read_b128 v[46:49], v26 offset:2352
    v_cvt_pk_bf16_f32 v198, v63, v28
    v_cvt_pk_bf16_f32 v199, v29, v30
    v_mfma_f32_16x16x32_bf16 v[84:87], v[184:187], a[44:47], v[84:87]
    v_mfma_f32_16x16x32_bf16 v[108:111], v[188:191], a[44:47], v[108:111]
    s_waitcnt lgkmcnt(4)
    v_mfma_f32_16x16x32_bf16 v[64:67], a[0:3], v[192:195], v[64:67]
    ds_read_b128 a[24:27], v4 offset:55296
    v_mfma_f32_16x16x32_bf16 v[88:91], a[0:3], v[196:199], v[88:91]
    ds_read_b128 a[28:31], v4 offset:56320
    buffer_load_dwordx4 v[232:235], v16, s[48:51], s25 offen
    buffer_load_dwordx4 v[236:239], v17, s[48:51], s25 offen
    v_mfma_f32_16x16x32_bf16 v[68:71], a[4:7], v[192:195], v[68:71]
    ds_read_b128 a[32:35], v4 offset:57344
    s_waitcnt vmcnt(18) lgkmcnt(3)
    v_fma_mix_f32 v51, v200, v32, v42 op_sel:[0,0,0] op_sel_hi:[1,0,0]
    v_fma_mix_f32 v52, v200, v33, v43 op_sel:[1,0,0] op_sel_hi:[1,0,0]
    v_fma_mix_f32 v53, v201, v34, v44 op_sel:[0,0,0] op_sel_hi:[1,0,0]
    v_fma_mix_f32 v54, v201, v35, v45 op_sel:[1,0,0] op_sel_hi:[1,0,0]
    v_mfma_f32_16x16x32_bf16 v[92:95], a[4:7], v[196:199], v[92:95]
    ds_read_b128 a[36:39], v4 offset:58368
    v_fma_mix_f32 v55, v202, v36, v46 op_sel:[0,0,0] op_sel_hi:[1,0,0]
    v_fma_mix_f32 v56, v202, v37, v47 op_sel:[1,0,0] op_sel_hi:[1,0,0]
    v_fma_mix_f32 v57, v203, v38, v48 op_sel:[0,0,0] op_sel_hi:[1,0,0]
    v_fma_mix_f32 v58, v203, v39, v49 op_sel:[1,0,0] op_sel_hi:[1,0,0]
    v_mfma_f32_16x16x32_bf16 v[72:75], a[8:11], v[192:195], v[72:75]
    ds_read_b128 a[40:43], v4 offset:59392
    v_fma_mix_f32 v59, v204, v32, v42 op_sel:[0,0,0] op_sel_hi:[1,0,0]
    v_fma_mix_f32 v60, v204, v33, v43 op_sel:[1,0,0] op_sel_hi:[1,0,0]
    v_fma_mix_f32 v61, v205, v34, v44 op_sel:[0,0,0] op_sel_hi:[1,0,0]
    v_fma_mix_f32 v62, v205, v35, v45 op_sel:[1,0,0] op_sel_hi:[1,0,0]
    buffer_load_dwordx4 a[64:67], v8, s[48:51], s36 offen sc1
    v_mfma_f32_16x16x32_bf16 v[96:99], a[8:11], v[196:199], v[96:99]
    ds_read_b128 a[44:47], v4 offset:60416
    v_fma_mix_f32 v63, v206, v36, v46 op_sel:[0,0,0] op_sel_hi:[1,0,0]
    v_fma_mix_f32 v28, v206, v37, v47 op_sel:[1,0,0] op_sel_hi:[1,0,0]
    v_fma_mix_f32 v29, v207, v38, v48 op_sel:[0,0,0] op_sel_hi:[1,0,0]
    v_fma_mix_f32 v30, v207, v39, v49 op_sel:[1,0,0] op_sel_hi:[1,0,0]
    v_mfma_f32_16x16x32_bf16 v[76:79], a[12:15], v[192:195], v[76:79]
    ds_read_b128 v[32:35], v26 offset:2560
    v_cvt_pk_bf16_f32 v200, v51, v52
    v_cvt_pk_bf16_f32 v201, v53, v54
    v_mfma_f32_16x16x32_bf16 v[100:103], a[12:15], v[196:199], v[100:103]
    ds_read_b128 v[36:39], v26 offset:2576
    v_cvt_pk_bf16_f32 v202, v55, v56
    v_cvt_pk_bf16_f32 v203, v57, v58
    s_add_u32 s79, s36, 16384
    buffer_load_dwordx4 a[68:71], v8, s[48:51], s79 offen sc1
    v_mfma_f32_16x16x32_bf16 v[80:83], v[192:195], a[16:19], v[80:83]
    ds_read_b128 v[42:45], v26 offset:2592
    v_cvt_pk_bf16_f32 v204, v59, v60
    v_cvt_pk_bf16_f32 v205, v61, v62
    v_mfma_f32_16x16x32_bf16 v[104:107], v[196:199], a[16:19], v[104:107]
    ds_read_b128 v[46:49], v26 offset:2608
    v_cvt_pk_bf16_f32 v206, v63, v28
    v_cvt_pk_bf16_f32 v207, v29, v30
    v_mfma_f32_16x16x32_bf16 v[84:87], v[192:195], a[20:23], v[84:87]
    s_add_u32 s79, s36, 32768
    buffer_load_dwordx4 a[72:75], v8, s[48:51], s79 offen sc1
    v_mfma_f32_16x16x32_bf16 v[108:111], v[196:199], a[20:23], v[108:111]
    s_waitcnt lgkmcnt(4)
    v_mfma_f32_16x16x32_bf16 v[64:67], a[24:27], v[200:203], v[64:67]
    ds_read_b128 a[0:3], v4 offset:61440
    v_mfma_f32_16x16x32_bf16 v[88:91], a[24:27], v[204:207], v[88:91]
    ds_read_b128 a[4:7], v4 offset:62464
    buffer_load_dwordx4 v[240:243], v16, s[48:51], s26 offen
    buffer_load_dwordx4 v[244:247], v17, s[48:51], s26 offen
    v_mfma_f32_16x16x32_bf16 v[68:71], a[28:31], v[200:203], v[68:71]
    ds_read_b128 a[8:11], v4 offset:63488
    s_waitcnt vmcnt(19) lgkmcnt(3)
    v_fma_mix_f32 v51, v208, v32, v42 op_sel:[0,0,0] op_sel_hi:[1,0,0]
    v_fma_mix_f32 v52, v208, v33, v43 op_sel:[1,0,0] op_sel_hi:[1,0,0]
    v_fma_mix_f32 v53, v209, v34, v44 op_sel:[0,0,0] op_sel_hi:[1,0,0]
    v_fma_mix_f32 v54, v209, v35, v45 op_sel:[1,0,0] op_sel_hi:[1,0,0]
    v_mfma_f32_16x16x32_bf16 v[92:95], a[28:31], v[204:207], v[92:95]
    ds_read_b128 a[12:15], v4 offset:64512
    v_fma_mix_f32 v55, v210, v36, v46 op_sel:[0,0,0] op_sel_hi:[1,0,0]
    v_fma_mix_f32 v56, v210, v37, v47 op_sel:[1,0,0] op_sel_hi:[1,0,0]
    v_fma_mix_f32 v57, v211, v38, v48 op_sel:[0,0,0] op_sel_hi:[1,0,0]
    v_fma_mix_f32 v58, v211, v39, v49 op_sel:[1,0,0] op_sel_hi:[1,0,0]
    v_mfma_f32_16x16x32_bf16 v[72:75], a[32:35], v[200:203], v[72:75]
    ds_read_b128 a[16:19], v19 offset:0
    v_fma_mix_f32 v59, v212, v32, v42 op_sel:[0,0,0] op_sel_hi:[1,0,0]
    v_fma_mix_f32 v60, v212, v33, v43 op_sel:[1,0,0] op_sel_hi:[1,0,0]
    v_fma_mix_f32 v61, v213, v34, v44 op_sel:[0,0,0] op_sel_hi:[1,0,0]
    v_fma_mix_f32 v62, v213, v35, v45 op_sel:[1,0,0] op_sel_hi:[1,0,0]
    s_add_u32 s79, s36, 49152
    buffer_load_dwordx4 a[76:79], v8, s[48:51], s79 offen sc1
    v_mfma_f32_16x16x32_bf16 v[96:99], a[32:35], v[204:207], v[96:99]
    ds_read_b128 a[20:23], v19 offset:1024
    v_fma_mix_f32 v63, v214, v36, v46 op_sel:[0,0,0] op_sel_hi:[1,0,0]
    v_fma_mix_f32 v28, v214, v37, v47 op_sel:[1,0,0] op_sel_hi:[1,0,0]
    v_fma_mix_f32 v29, v215, v38, v48 op_sel:[0,0,0] op_sel_hi:[1,0,0]
    v_fma_mix_f32 v30, v215, v39, v49 op_sel:[1,0,0] op_sel_hi:[1,0,0]
    v_mfma_f32_16x16x32_bf16 v[76:79], a[36:39], v[200:203], v[76:79]
    ds_read_b128 v[32:35], v26 offset:2816
    v_cvt_pk_bf16_f32 v208, v51, v52
    v_cvt_pk_bf16_f32 v209, v53, v54
    v_mfma_f32_16x16x32_bf16 v[100:103], a[36:39], v[204:207], v[100:103]
    ds_read_b128 v[36:39], v26 offset:2832
    v_cvt_pk_bf16_f32 v210, v55, v56
    v_cvt_pk_bf16_f32 v211, v57, v58
    buffer_load_dwordx4 a[80:83], v8, s[48:51], s37 offen sc1
    v_mfma_f32_16x16x32_bf16 v[80:83], v[200:203], a[40:43], v[80:83]
    ds_read_b128 v[42:45], v26 offset:2848
    v_cvt_pk_bf16_f32 v212, v59, v60
    v_cvt_pk_bf16_f32 v213, v61, v62
    v_mfma_f32_16x16x32_bf16 v[104:107], v[204:207], a[40:43], v[104:107]
    ds_read_b128 v[46:49], v26 offset:2864
    v_cvt_pk_bf16_f32 v214, v63, v28
    v_cvt_pk_bf16_f32 v215, v29, v30
    v_mfma_f32_16x16x32_bf16 v[84:87], v[200:203], a[44:47], v[84:87]
    s_add_u32 s79, s37, 16384
    buffer_load_dwordx4 a[84:87], v8, s[48:51], s79 offen sc1
    v_mfma_f32_16x16x32_bf16 v[108:111], v[204:207], a[44:47], v[108:111]
    s_waitcnt lgkmcnt(4)
    v_mfma_f32_16x16x32_bf16 v[64:67], a[0:3], v[208:211], v[64:67]
    ds_read_b128 a[24:27], v19 offset:2048
    v_mfma_f32_16x16x32_bf16 v[88:91], a[0:3], v[212:215], v[88:91]
    ds_read_b128 a[28:31], v19 offset:3072
    buffer_load_dwordx4 v[248:251], v16, s[48:51], s27 offen
    buffer_load_dwordx4 v[252:255], v17, s[48:51], s27 offen
    v_mfma_f32_16x16x32_bf16 v[68:71], a[4:7], v[208:211], v[68:71]
    ds_read_b128 a[32:35], v19 offset:4096
    s_waitcnt vmcnt(20) lgkmcnt(3)
    v_fma_mix_f32 v51, v216, v32, v42 op_sel:[0,0,0] op_sel_hi:[1,0,0]
    v_fma_mix_f32 v52, v216, v33, v43 op_sel:[1,0,0] op_sel_hi:[1,0,0]
    v_fma_mix_f32 v53, v217, v34, v44 op_sel:[0,0,0] op_sel_hi:[1,0,0]
    v_fma_mix_f32 v54, v217, v35, v45 op_sel:[1,0,0] op_sel_hi:[1,0,0]
    v_mfma_f32_16x16x32_bf16 v[92:95], a[4:7], v[212:215], v[92:95]
    ds_read_b128 a[36:39], v19 offset:5120
    v_fma_mix_f32 v55, v218, v36, v46 op_sel:[0,0,0] op_sel_hi:[1,0,0]
    v_fma_mix_f32 v56, v218, v37, v47 op_sel:[1,0,0] op_sel_hi:[1,0,0]
    v_fma_mix_f32 v57, v219, v38, v48 op_sel:[0,0,0] op_sel_hi:[1,0,0]
    v_fma_mix_f32 v58, v219, v39, v49 op_sel:[1,0,0] op_sel_hi:[1,0,0]
    v_mfma_f32_16x16x32_bf16 v[72:75], a[8:11], v[208:211], v[72:75]
    ds_read_b128 a[40:43], v19 offset:6144
    v_fma_mix_f32 v59, v220, v32, v42 op_sel:[0,0,0] op_sel_hi:[1,0,0]
    v_fma_mix_f32 v60, v220, v33, v43 op_sel:[1,0,0] op_sel_hi:[1,0,0]
    v_fma_mix_f32 v61, v221, v34, v44 op_sel:[0,0,0] op_sel_hi:[1,0,0]
    v_fma_mix_f32 v62, v221, v35, v45 op_sel:[1,0,0] op_sel_hi:[1,0,0]
    s_add_u32 s79, s37, 32768
    buffer_load_dwordx4 a[88:91], v8, s[48:51], s79 offen sc1
    v_mfma_f32_16x16x32_bf16 v[96:99], a[8:11], v[212:215], v[96:99]
    ds_read_b128 a[44:47], v19 offset:7168
    v_fma_mix_f32 v63, v222, v36, v46 op_sel:[0,0,0] op_sel_hi:[1,0,0]
    v_fma_mix_f32 v28, v222, v37, v47 op_sel:[1,0,0] op_sel_hi:[1,0,0]
    v_fma_mix_f32 v29, v223, v38, v48 op_sel:[0,0,0] op_sel_hi:[1,0,0]
    v_fma_mix_f32 v30, v223, v39, v49 op_sel:[1,0,0] op_sel_hi:[1,0,0]
    v_mfma_f32_16x16x32_bf16 v[76:79], a[12:15], v[208:211], v[76:79]
    ds_read_b128 v[32:35], v26 offset:3072
    v_cvt_pk_bf16_f32 v216, v51, v52
    v_cvt_pk_bf16_f32 v217, v53, v54
    v_mfma_f32_16x16x32_bf16 v[100:103], a[12:15], v[212:215], v[100:103]
    ds_read_b128 v[36:39], v26 offset:3088
    v_cvt_pk_bf16_f32 v218, v55, v56
    v_cvt_pk_bf16_f32 v219, v57, v58
    s_add_u32 s79, s37, 49152
    buffer_load_dwordx4 a[92:95], v8, s[48:51], s79 offen sc1
    v_mfma_f32_16x16x32_bf16 v[80:83], v[208:211], a[16:19], v[80:83]
    ds_read_b128 v[42:45], v26 offset:3104
    v_cvt_pk_bf16_f32 v220, v59, v60
    v_cvt_pk_bf16_f32 v221, v61, v62
    v_mfma_f32_16x16x32_bf16 v[104:107], v[212:215], a[16:19], v[104:107]
    ds_read_b128 v[46:49], v26 offset:3120
    v_cvt_pk_bf16_f32 v222, v63, v28
    v_cvt_pk_bf16_f32 v223, v29, v30
    v_mfma_f32_16x16x32_bf16 v[84:87], v[208:211], a[20:23], v[84:87]
    buffer_load_dwordx4 a[96:99], v8, s[48:51], s38 offen sc1
    v_mfma_f32_16x16x32_bf16 v[108:111], v[212:215], a[20:23], v[108:111]
    s_waitcnt vmcnt(21)
    s_barrier
    s_waitcnt lgkmcnt(4)
    v_mfma_f32_16x16x32_bf16 v[64:67], a[24:27], v[216:219], v[64:67]
    ds_read_b128 a[0:3], v19 offset:8192
    v_mfma_f32_16x16x32_bf16 v[88:91], a[24:27], v[220:223], v[88:91]
    ds_read_b128 a[4:7], v19 offset:9216
    buffer_load_dwordx4 a[48:51], v18, s[48:51], s82 offen
    v_mfma_f32_16x16x32_bf16 v[68:71], a[28:31], v[216:219], v[68:71]
    ds_read_b128 a[8:11], v19 offset:10240
    s_waitcnt vmcnt(16) lgkmcnt(3)
    v_fma_mix_f32 v51, v224, v32, v42 op_sel:[0,0,0] op_sel_hi:[1,0,0]
    v_fma_mix_f32 v52, v224, v33, v43 op_sel:[1,0,0] op_sel_hi:[1,0,0]
    v_fma_mix_f32 v53, v225, v34, v44 op_sel:[0,0,0] op_sel_hi:[1,0,0]
    v_fma_mix_f32 v54, v225, v35, v45 op_sel:[1,0,0] op_sel_hi:[1,0,0]
    v_mfma_f32_16x16x32_bf16 v[92:95], a[28:31], v[220:223], v[92:95]
    ds_read_b128 a[12:15], v19 offset:11264
    v_fma_mix_f32 v55, v226, v36, v46 op_sel:[0,0,0] op_sel_hi:[1,0,0]
    v_fma_mix_f32 v56, v226, v37, v47 op_sel:[1,0,0] op_sel_hi:[1,0,0]
    v_fma_mix_f32 v57, v227, v38, v48 op_sel:[0,0,0] op_sel_hi:[1,0,0]
    v_fma_mix_f32 v58, v227, v39, v49 op_sel:[1,0,0] op_sel_hi:[1,0,0]
    v_mfma_f32_16x16x32_bf16 v[72:75], a[32:35], v[216:219], v[72:75]
    ds_read_b128 a[16:19], v19 offset:12288
    v_fma_mix_f32 v59, v228, v32, v42 op_sel:[0,0,0] op_sel_hi:[1,0,0]
    v_fma_mix_f32 v60, v228, v33, v43 op_sel:[1,0,0] op_sel_hi:[1,0,0]
    v_fma_mix_f32 v61, v229, v34, v44 op_sel:[0,0,0] op_sel_hi:[1,0,0]
    v_fma_mix_f32 v62, v229, v35, v45 op_sel:[1,0,0] op_sel_hi:[1,0,0]
    buffer_load_dwordx4 a[52:55], v18, s[48:51], s83 offen
    v_mfma_f32_16x16x32_bf16 v[96:99], a[32:35], v[220:223], v[96:99]
    ds_read_b128 a[20:23], v19 offset:13312
    v_fma_mix_f32 v63, v230, v36, v46 op_sel:[0,0,0] op_sel_hi:[1,0,0]
    v_fma_mix_f32 v28, v230, v37, v47 op_sel:[1,0,0] op_sel_hi:[1,0,0]
    v_fma_mix_f32 v29, v231, v38, v48 op_sel:[0,0,0] op_sel_hi:[1,0,0]
    v_fma_mix_f32 v30, v231, v39, v49 op_sel:[1,0,0] op_sel_hi:[1,0,0]
    v_mfma_f32_16x16x32_bf16 v[76:79], a[36:39], v[216:219], v[76:79]
    ds_read_b128 v[32:35], v26 offset:3328
    v_cvt_pk_bf16_f32 v224, v51, v52
    v_cvt_pk_bf16_f32 v225, v53, v54
    v_mfma_f32_16x16x32_bf16 v[100:103], a[36:39], v[220:223], v[100:103]
    ds_read_b128 v[36:39], v26 offset:3344
    v_cvt_pk_bf16_f32 v226, v55, v56
    v_cvt_pk_bf16_f32 v227, v57, v58
    v_mfma_f32_16x16x32_bf16 v[80:83], v[216:219], a[40:43], v[80:83]
    ds_read_b128 v[42:45], v26 offset:3360
    v_cvt_pk_bf16_f32 v228, v59, v60
    v_cvt_pk_bf16_f32 v229, v61, v62
    v_mfma_f32_16x16x32_bf16 v[104:107], v[220:223], a[40:43], v[104:107]
    ds_read_b128 v[46:49], v26 offset:3376
    v_cvt_pk_bf16_f32 v230, v63, v28
    v_cvt_pk_bf16_f32 v231, v29, v30
    v_mfma_f32_16x16x32_bf16 v[84:87], v[216:219], a[44:47], v[84:87]
    v_mfma_f32_16x16x32_bf16 v[108:111], v[220:223], a[44:47], v[108:111]
    s_waitcnt lgkmcnt(4)
    v_mfma_f32_16x16x32_bf16 v[64:67], a[0:3], v[224:227], v[64:67]
    ds_read_b128 a[24:27], v19 offset:14336
    v_mfma_f32_16x16x32_bf16 v[88:91], a[0:3], v[228:231], v[88:91]
    ds_read_b128 a[28:31], v19 offset:15360
    buffer_load_dwordx4 a[56:59], v18, s[48:51], s84 offen
    v_mfma_f32_16x16x32_bf16 v[68:71], a[4:7], v[224:227], v[68:71]
    ds_read_b128 a[32:35], v19 offset:16384
    s_waitcnt vmcnt(16) lgkmcnt(3)
    v_fma_mix_f32 v51, v232, v32, v42 op_sel:[0,0,0] op_sel_hi:[1,0,0]
    v_fma_mix_f32 v52, v232, v33, v43 op_sel:[1,0,0] op_sel_hi:[1,0,0]
    v_fma_mix_f32 v53, v233, v34, v44 op_sel:[0,0,0] op_sel_hi:[1,0,0]
    v_fma_mix_f32 v54, v233, v35, v45 op_sel:[1,0,0] op_sel_hi:[1,0,0]
    v_mfma_f32_16x16x32_bf16 v[92:95], a[4:7], v[228:231], v[92:95]
    ds_read_b128 a[36:39], v19 offset:17408
    v_fma_mix_f32 v55, v234, v36, v46 op_sel:[0,0,0] op_sel_hi:[1,0,0]
    v_fma_mix_f32 v56, v234, v37, v47 op_sel:[1,0,0] op_sel_hi:[1,0,0]
    v_fma_mix_f32 v57, v235, v38, v48 op_sel:[0,0,0] op_sel_hi:[1,0,0]
    v_fma_mix_f32 v58, v235, v39, v49 op_sel:[1,0,0] op_sel_hi:[1,0,0]
    v_mfma_f32_16x16x32_bf16 v[72:75], a[8:11], v[224:227], v[72:75]
    ds_read_b128 a[40:43], v19 offset:18432
    v_fma_mix_f32 v59, v236, v32, v42 op_sel:[0,0,0] op_sel_hi:[1,0,0]
    v_fma_mix_f32 v60, v236, v33, v43 op_sel:[1,0,0] op_sel_hi:[1,0,0]
    v_fma_mix_f32 v61, v237, v34, v44 op_sel:[0,0,0] op_sel_hi:[1,0,0]
    v_fma_mix_f32 v62, v237, v35, v45 op_sel:[1,0,0] op_sel_hi:[1,0,0]
    buffer_load_dwordx4 a[60:63], v18, s[48:51], s85 offen
    v_mfma_f32_16x16x32_bf16 v[96:99], a[8:11], v[228:231], v[96:99]
    ds_read_b128 a[44:47], v19 offset:19456
    v_fma_mix_f32 v63, v238, v36, v46 op_sel:[0,0,0] op_sel_hi:[1,0,0]
    v_fma_mix_f32 v28, v238, v37, v47 op_sel:[1,0,0] op_sel_hi:[1,0,0]
    v_fma_mix_f32 v29, v239, v38, v48 op_sel:[0,0,0] op_sel_hi:[1,0,0]
    v_fma_mix_f32 v30, v239, v39, v49 op_sel:[1,0,0] op_sel_hi:[1,0,0]
    v_mfma_f32_16x16x32_bf16 v[76:79], a[12:15], v[224:227], v[76:79]
    ds_read_b128 v[32:35], v26 offset:3584
    v_cvt_pk_bf16_f32 v232, v51, v52
    v_cvt_pk_bf16_f32 v233, v53, v54
    v_mfma_f32_16x16x32_bf16 v[100:103], a[12:15], v[228:231], v[100:103]
    ds_read_b128 v[36:39], v26 offset:3600
    v_cvt_pk_bf16_f32 v234, v55, v56
    v_cvt_pk_bf16_f32 v235, v57, v58
    v_mfma_f32_16x16x32_bf16 v[80:83], v[224:227], a[16:19], v[80:83]
    ds_read_b128 v[42:45], v26 offset:3616
    v_cvt_pk_bf16_f32 v236, v59, v60
    v_cvt_pk_bf16_f32 v237, v61, v62
    v_mfma_f32_16x16x32_bf16 v[104:107], v[228:231], a[16:19], v[104:107]
    ds_read_b128 v[46:49], v26 offset:3632
    v_cvt_pk_bf16_f32 v238, v63, v28
    v_cvt_pk_bf16_f32 v239, v29, v30
    v_mfma_f32_16x16x32_bf16 v[84:87], v[224:227], a[20:23], v[84:87]
    v_mfma_f32_16x16x32_bf16 v[108:111], v[228:231], a[20:23], v[108:111]
    s_waitcnt lgkmcnt(4)
    v_mfma_f32_16x16x32_bf16 v[64:67], a[24:27], v[232:235], v[64:67]
    ds_read_b128 a[0:3], v19 offset:20480
    v_mfma_f32_16x16x32_bf16 v[88:91], a[24:27], v[236:239], v[88:91]
    ds_read_b128 a[4:7], v19 offset:21504
    s_add_u32 s79, s38, 16384
    buffer_load_dwordx4 a[100:103], v8, s[48:51], s79 offen sc1
    v_mfma_f32_16x16x32_bf16 v[68:71], a[28:31], v[232:235], v[68:71]
    ds_read_b128 a[8:11], v19 offset:22528
    s_waitcnt vmcnt(13) lgkmcnt(3)
    v_fma_mix_f32 v51, v240, v32, v42 op_sel:[0,0,0] op_sel_hi:[1,0,0]
    v_fma_mix_f32 v52, v240, v33, v43 op_sel:[1,0,0] op_sel_hi:[1,0,0]
    v_fma_mix_f32 v53, v241, v34, v44 op_sel:[0,0,0] op_sel_hi:[1,0,0]
    v_fma_mix_f32 v54, v241, v35, v45 op_sel:[1,0,0] op_sel_hi:[1,0,0]
    v_mfma_f32_16x16x32_bf16 v[92:95], a[28:31], v[236:239], v[92:95]
    ds_read_b128 a[12:15], v19 offset:23552
    v_fma_mix_f32 v55, v242, v36, v46 op_sel:[0,0,0] op_sel_hi:[1,0,0]
    v_fma_mix_f32 v56, v242, v37, v47 op_sel:[1,0,0] op_sel_hi:[1,0,0]
    v_fma_mix_f32 v57, v243, v38, v48 op_sel:[0,0,0] op_sel_hi:[1,0,0]
    v_fma_mix_f32 v58, v243, v39, v49 op_sel:[1,0,0] op_sel_hi:[1,0,0]
    v_mfma_f32_16x16x32_bf16 v[72:75], a[32:35], v[232:235], v[72:75]
    ds_read_b128 a[16:19], v19 offset:24576
    v_fma_mix_f32 v59, v244, v32, v42 op_sel:[0,0,0] op_sel_hi:[1,0,0]
    v_fma_mix_f32 v60, v244, v33, v43 op_sel:[1,0,0] op_sel_hi:[1,0,0]
    v_fma_mix_f32 v61, v245, v34, v44 op_sel:[0,0,0] op_sel_hi:[1,0,0]
    v_fma_mix_f32 v62, v245, v35, v45 op_sel:[1,0,0] op_sel_hi:[1,0,0]
    s_add_u32 s79, s38, 32768
    buffer_load_dwordx4 a[104:107], v8, s[48:51], s79 offen sc1
    v_mfma_f32_16x16x32_bf16 v[96:99], a[32:35], v[236:239], v[96:99]
    ds_read_b128 a[20:23], v19 offset:25600
    v_fma_mix_f32 v63, v246, v36, v46 op_sel:[0,0,0] op_sel_hi:[1,0,0]
    v_fma_mix_f32 v28, v246, v37, v47 op_sel:[1,0,0] op_sel_hi:[1,0,0]
    v_fma_mix_f32 v29, v247, v38, v48 op_sel:[0,0,0] op_sel_hi:[1,0,0]
    v_fma_mix_f32 v30, v247, v39, v49 op_sel:[1,0,0] op_sel_hi:[1,0,0]
    v_mfma_f32_16x16x32_bf16 v[76:79], a[36:39], v[232:235], v[76:79]
    ds_read_b128 v[32:35], v26 offset:3840
    v_cvt_pk_bf16_f32 v240, v51, v52
    v_cvt_pk_bf16_f32 v241, v53, v54
    v_mfma_f32_16x16x32_bf16 v[100:103], a[36:39], v[236:239], v[100:103]
    ds_read_b128 v[36:39], v26 offset:3856
    v_cvt_pk_bf16_f32 v242, v55, v56
    v_cvt_pk_bf16_f32 v243, v57, v58
    s_add_u32 s79, s38, 49152
    buffer_load_dwordx4 a[108:111], v8, s[48:51], s79 offen sc1
    v_mfma_f32_16x16x32_bf16 v[80:83], v[232:235], a[40:43], v[80:83]
    ds_read_b128 v[42:45], v26 offset:3872
    v_cvt_pk_bf16_f32 v244, v59, v60
    v_cvt_pk_bf16_f32 v245, v61, v62
    v_mfma_f32_16x16x32_bf16 v[104:107], v[236:239], a[40:43], v[104:107]
    ds_read_b128 v[46:49], v26 offset:3888
    v_cvt_pk_bf16_f32 v246, v63, v28
    v_cvt_pk_bf16_f32 v247, v29, v30
    v_mfma_f32_16x16x32_bf16 v[84:87], v[232:235], a[44:47], v[84:87]
    v_mfma_f32_16x16x32_bf16 v[108:111], v[236:239], a[44:47], v[108:111]
    s_waitcnt lgkmcnt(4)
    v_mfma_f32_16x16x32_bf16 v[64:67], a[0:3], v[240:243], v[64:67]
    ds_read_b128 a[24:27], v19 offset:26624
    v_mfma_f32_16x16x32_bf16 v[88:91], a[0:3], v[244:247], v[88:91]
    ds_read_b128 a[28:31], v19 offset:27648
    buffer_load_dwordx4 a[112:115], v8, s[48:51], s39 offen sc1
    v_mfma_f32_16x16x32_bf16 v[68:71], a[4:7], v[240:243], v[68:71]
    ds_read_b128 a[32:35], v19 offset:28672
    s_waitcnt vmcnt(11) lgkmcnt(3)
    v_fma_mix_f32 v51, v248, v32, v42 op_sel:[0,0,0] op_sel_hi:[1,0,0]
    v_fma_mix_f32 v52, v248, v33, v43 op_sel:[1,0,0] op_sel_hi:[1,0,0]
    v_fma_mix_f32 v53, v249, v34, v44 op_sel:[0,0,0] op_sel_hi:[1,0,0]
    v_fma_mix_f32 v54, v249, v35, v45 op_sel:[1,0,0] op_sel_hi:[1,0,0]
    v_mfma_f32_16x16x32_bf16 v[92:95], a[4:7], v[244:247], v[92:95]
    ds_read_b128 a[36:39], v19 offset:29696
    v_fma_mix_f32 v55, v250, v36, v46 op_sel:[0,0,0] op_sel_hi:[1,0,0]
    v_fma_mix_f32 v56, v250, v37, v47 op_sel:[1,0,0] op_sel_hi:[1,0,0]
    v_fma_mix_f32 v57, v251, v38, v48 op_sel:[0,0,0] op_sel_hi:[1,0,0]
    v_fma_mix_f32 v58, v251, v39, v49 op_sel:[1,0,0] op_sel_hi:[1,0,0]
    v_mfma_f32_16x16x32_bf16 v[72:75], a[8:11], v[240:243], v[72:75]
    ds_read_b128 a[40:43], v19 offset:30720
    v_fma_mix_f32 v59, v252, v32, v42 op_sel:[0,0,0] op_sel_hi:[1,0,0]
    v_fma_mix_f32 v60, v252, v33, v43 op_sel:[1,0,0] op_sel_hi:[1,0,0]
    v_fma_mix_f32 v61, v253, v34, v44 op_sel:[0,0,0] op_sel_hi:[1,0,0]
    v_fma_mix_f32 v62, v253, v35, v45 op_sel:[1,0,0] op_sel_hi:[1,0,0]
    s_add_u32 s79, s39, 16384
    buffer_load_dwordx4 a[116:119], v8, s[48:51], s79 offen sc1
    v_mfma_f32_16x16x32_bf16 v[96:99], a[8:11], v[244:247], v[96:99]
    ds_read_b128 a[44:47], v19 offset:31744
    v_fma_mix_f32 v63, v254, v36, v46 op_sel:[0,0,0] op_sel_hi:[1,0,0]
    v_fma_mix_f32 v28, v254, v37, v47 op_sel:[1,0,0] op_sel_hi:[1,0,0]
    v_fma_mix_f32 v29, v255, v38, v48 op_sel:[0,0,0] op_sel_hi:[1,0,0]
    v_fma_mix_f32 v30, v255, v39, v49 op_sel:[1,0,0] op_sel_hi:[1,0,0]
    v_mfma_f32_16x16x32_bf16 v[76:79], a[12:15], v[240:243], v[76:79]
    v_cvt_pk_bf16_f32 v248, v51, v52
    v_cvt_pk_bf16_f32 v249, v53, v54
    v_mfma_f32_16x16x32_bf16 v[100:103], a[12:15], v[244:247], v[100:103]
    v_cvt_pk_bf16_f32 v250, v55, v56
    v_cvt_pk_bf16_f32 v251, v57, v58
    s_add_u32 s79, s39, 32768
    buffer_load_dwordx4 a[120:123], v8, s[48:51], s79 offen sc1
    v_mfma_f32_16x16x32_bf16 v[80:83], v[240:243], a[16:19], v[80:83]
    v_cvt_pk_bf16_f32 v252, v59, v60
    v_cvt_pk_bf16_f32 v253, v61, v62
    v_mfma_f32_16x16x32_bf16 v[104:107], v[244:247], a[16:19], v[104:107]
    v_cvt_pk_bf16_f32 v254, v63, v28
    v_cvt_pk_bf16_f32 v255, v29, v30
    v_mfma_f32_16x16x32_bf16 v[84:87], v[240:243], a[20:23], v[84:87]
    v_mfma_f32_16x16x32_bf16 v[108:111], v[244:247], a[20:23], v[108:111]
    s_waitcnt lgkmcnt(0)
    v_mfma_f32_16x16x32_bf16 v[64:67], a[24:27], v[248:251], v[64:67]
    v_mfma_f32_16x16x32_bf16 v[88:91], a[24:27], v[252:255], v[88:91]
    s_add_u32 s79, s39, 49152
    buffer_load_dwordx4 a[124:127], v8, s[48:51], s79 offen sc1
    v_mfma_f32_16x16x32_bf16 v[68:71], a[28:31], v[248:251], v[68:71]
    v_mfma_f32_16x16x32_bf16 v[92:95], a[28:31], v[252:255], v[92:95]
    v_mfma_f32_16x16x32_bf16 v[72:75], a[32:35], v[248:251], v[72:75]
    v_mfma_f32_16x16x32_bf16 v[96:99], a[32:35], v[252:255], v[96:99]
    v_mfma_f32_16x16x32_bf16 v[76:79], a[36:39], v[248:251], v[76:79]
    v_mfma_f32_16x16x32_bf16 v[100:103], a[36:39], v[252:255], v[100:103]
    v_mfma_f32_16x16x32_bf16 v[80:83], v[248:251], a[40:43], v[80:83]
    v_mfma_f32_16x16x32_bf16 v[104:107], v[252:255], a[40:43], v[104:107]
    v_mfma_f32_16x16x32_bf16 v[84:87], v[248:251], a[44:47], v[84:87]
    v_mfma_f32_16x16x32_bf16 v[108:111], v[252:255], a[44:47], v[108:111]
    s_mul_i32 s6, s3, 24576
    v_add_u32 v27, s6, v4
    s_lshl_b32 s6, s3, 10
    v_add_u32 v31, s6, v26
    ds_read_b128 v[128:131], v31 offset:0
    ds_read_b128 v[132:135], v31 offset:16
    s_add_u32 m0, s76, 98304
    s_nop 0
    buffer_load_dwordx4 v12, s[48:51], s12 offen sc1 lds
    ds_read_b128 v[138:141], v31 offset:32
    ds_read_b128 v[142:145], v31 offset:48
    ds_read_b128 v[148:151], v31 offset:256
    ds_read_b128 v[152:155], v31 offset:272
    ds_read_b128 v[158:161], v31 offset:288
    ds_read_b128 v[162:165], v31 offset:304
    s_add_u32 m0, s76, 102400
    s_nop 0
    buffer_load_dwordx4 v12, s[48:51], s13 offen sc1 lds
    ds_read_b128 v[168:171], v31 offset:512
    ds_read_b128 v[172:175], v31 offset:528
    ds_read_b128 v[178:181], v31 offset:544
    ds_read_b128 v[182:185], v31 offset:560
    ds_read_b128 v[188:191], v31 offset:768
    ds_read_b128 v[192:195], v31 offset:784
    s_add_u32 m0, s76, 106496
    s_nop 0
    buffer_load_dwordx4 v12, s[48:51], s14 offen sc1 lds
    ds_read_b128 v[198:201], v31 offset:800
    ds_read_b128 v[202:205], v31 offset:816
    ds_read_b128 a[8:11], v27 offset:2048
    ds_read_b128 a[12:15], v27 offset:3072
    ds_read_b128 a[16:19], v27 offset:4096
    ds_read_b128 a[20:23], v27 offset:5120
    s_add_u32 m0, s76, 110592
    s_nop 0
    buffer_load_dwordx4 v12, s[48:51], s15 offen sc1 lds
    ds_read_b128 a[32:35], v27 offset:8192
    ds_read_b128 a[36:39], v27 offset:9216
    ds_read_b128 a[40:43], v27 offset:10240
    ds_read_b128 a[44:47], v27 offset:11264
    s_waitcnt vmcnt(11)
    v_accvgpr_read_b32 v208, a48
    s_add_u32 m0, s76, 114688
    s_nop 0
    buffer_load_dwordx4 v12, s[48:51], s16 offen sc1 lds
    v_accvgpr_read_b32 v209, a49
    v_accvgpr_read_b32 v210, a50
    v_accvgpr_read_b32 v211, a51
    v_accvgpr_read_b32 v212, a52
    v_accvgpr_read_b32 v213, a53
    v_accvgpr_read_b32 v214, a54
    s_add_u32 m0, s76, 118784
    s_nop 0
    buffer_load_dwordx4 v12, s[48:51], s17 offen sc1 lds
    v_accvgpr_read_b32 v215, a55
    v_accvgpr_read_b32 v216, a56
    v_accvgpr_read_b32 v217, a57
    v_accvgpr_read_b32 v218, a58
    v_accvgpr_read_b32 v219, a59
    v_accvgpr_read_b32 v220, a60
    s_add_u32 m0, s76, 122880
    s_nop 0
    buffer_load_dwordx4 v12, s[48:51], s18 offen sc1 lds
    v_accvgpr_read_b32 v221, a61
    v_accvgpr_read_b32 v222, a62
    v_accvgpr_read_b32 v223, a63
    s_waitcnt lgkmcnt(8)
    v_fma_mix_f32 v51, v208, v128, v138 op_sel:[0,0,0] op_sel_hi:[1,0,0]
    v_fma_mix_f32 v52, v208, v129, v139 op_sel:[1,0,0] op_sel_hi:[1,0,0]
    s_add_u32 m0, s76, 126976
    s_nop 0
    buffer_load_dwordx4 v12, s[48:51], s19 offen sc1 lds
    v_fma_mix_f32 v53, v209, v130, v140 op_sel:[0,0,0] op_sel_hi:[1,0,0]
    v_fma_mix_f32 v54, v209, v131, v141 op_sel:[1,0,0] op_sel_hi:[1,0,0]
    v_fma_mix_f32 v55, v210, v132, v142 op_sel:[0,0,0] op_sel_hi:[1,0,0]
    v_fma_mix_f32 v56, v210, v133, v143 op_sel:[1,0,0] op_sel_hi:[1,0,0]
    v_fma_mix_f32 v57, v211, v134, v144 op_sel:[0,0,0] op_sel_hi:[1,0,0]
    v_fma_mix_f32 v58, v211, v135, v145 op_sel:[1,0,0] op_sel_hi:[1,0,0]
    s_add_u32 m0, s76, 131072
    s_nop 0
    buffer_load_dwordx4 v12, s[48:51], s20 offen sc1 lds
    v_fma_mix_f32 v59, v212, v148, v158 op_sel:[0,0,0] op_sel_hi:[1,0,0]
    v_fma_mix_f32 v60, v212, v149, v159 op_sel:[1,0,0] op_sel_hi:[1,0,0]
    v_fma_mix_f32 v61, v213, v150, v160 op_sel:[0,0,0] op_sel_hi:[1,0,0]
    v_fma_mix_f32 v62, v213, v151, v161 op_sel:[1,0,0] op_sel_hi:[1,0,0]
    v_fma_mix_f32 v63, v214, v152, v162 op_sel:[0,0,0] op_sel_hi:[1,0,0]
    v_fma_mix_f32 v28, v214, v153, v163 op_sel:[1,0,0] op_sel_hi:[1,0,0]
    s_add_u32 m0, s76, 135168
    s_nop 0
    buffer_load_dwordx4 v12, s[48:51], s21 offen sc1 lds
    v_fma_mix_f32 v29, v215, v154, v164 op_sel:[0,0,0] op_sel_hi:[1,0,0]
    v_fma_mix_f32 v30, v215, v155, v165 op_sel:[1,0,0] op_sel_hi:[1,0,0]
    v_cvt_pk_bf16_f32 v208, v51, v52
    v_cvt_pk_bf16_f32 v209, v53, v54
    v_cvt_pk_bf16_f32 v210, v55, v56
    v_cvt_pk_bf16_f32 v211, v57, v58
    s_add_u32 m0, s76, 139264
    s_nop 0
    buffer_load_dwordx4 v12, s[48:51], s22 offen sc1 lds
    v_cvt_pk_bf16_f32 v212, v59, v60
    v_cvt_pk_bf16_f32 v213, v61, v62
    v_cvt_pk_bf16_f32 v214, v63, v28
    v_cvt_pk_bf16_f32 v215, v29, v30
    v_fma_mix_f32 v51, v216, v168, v178 op_sel:[0,0,0] op_sel_hi:[1,0,0]
    v_fma_mix_f32 v52, v216, v169, v179 op_sel:[1,0,0] op_sel_hi:[1,0,0]
    s_add_u32 m0, s76, 143360
    s_nop 0
    buffer_load_dwordx4 v12, s[48:51], s23 offen sc1 lds
    v_fma_mix_f32 v53, v217, v170, v180 op_sel:[0,0,0] op_sel_hi:[1,0,0]
    v_fma_mix_f32 v54, v217, v171, v181 op_sel:[1,0,0] op_sel_hi:[1,0,0]
    v_fma_mix_f32 v55, v218, v172, v182 op_sel:[0,0,0] op_sel_hi:[1,0,0]
    v_fma_mix_f32 v56, v218, v173, v183 op_sel:[1,0,0] op_sel_hi:[1,0,0]
    v_fma_mix_f32 v57, v219, v174, v184 op_sel:[0,0,0] op_sel_hi:[1,0,0]
    v_fma_mix_f32 v58, v219, v175, v185 op_sel:[1,0,0] op_sel_hi:[1,0,0]
    v_fma_mix_f32 v59, v220, v188, v198 op_sel:[0,0,0] op_sel_hi:[1,0,0]
    v_fma_mix_f32 v60, v220, v189, v199 op_sel:[1,0,0] op_sel_hi:[1,0,0]
    v_fma_mix_f32 v61, v221, v190, v200 op_sel:[0,0,0] op_sel_hi:[1,0,0]
    v_fma_mix_f32 v62, v221, v191, v201 op_sel:[1,0,0] op_sel_hi:[1,0,0]
    v_fma_mix_f32 v63, v222, v192, v202 op_sel:[0,0,0] op_sel_hi:[1,0,0]
    v_fma_mix_f32 v28, v222, v193, v203 op_sel:[1,0,0] op_sel_hi:[1,0,0]
    v_fma_mix_f32 v29, v223, v194, v204 op_sel:[0,0,0] op_sel_hi:[1,0,0]
    v_fma_mix_f32 v30, v223, v195, v205 op_sel:[1,0,0] op_sel_hi:[1,0,0]
    v_cvt_pk_bf16_f32 v216, v51, v52
    v_cvt_pk_bf16_f32 v217, v53, v54
    v_cvt_pk_bf16_f32 v218, v55, v56
    v_cvt_pk_bf16_f32 v219, v57, v58
    v_cvt_pk_bf16_f32 v220, v59, v60
    v_cvt_pk_bf16_f32 v221, v61, v62
    v_cvt_pk_bf16_f32 v222, v63, v28
    v_cvt_pk_bf16_f32 v223, v29, v30
    s_waitcnt lgkmcnt(0)
    v_mfma_f32_16x16x32_bf16 v[112:115], a[8:11], v[208:211], 0
    v_mfma_f32_16x16x32_bf16 v[116:119], a[12:15], v[208:211], 0
    v_mfma_f32_16x16x32_bf16 v[120:123], v[208:211], a[16:19], 0
    v_mfma_f32_16x16x32_bf16 v[124:127], v[208:211], a[20:23], 0
    v_mfma_f32_16x16x32_bf16 v[112:115], a[32:35], v[212:215], v[112:115]
    v_mfma_f32_16x16x32_bf16 v[116:119], a[36:39], v[212:215], v[116:119]
    v_mfma_f32_16x16x32_bf16 v[120:123], v[212:215], a[40:43], v[120:123]
    v_mfma_f32_16x16x32_bf16 v[124:127], v[212:215], a[44:47], v[124:127]
    ds_read_b128 a[8:11], v27 offset:14336
    ds_read_b128 a[12:15], v27 offset:15360
    ds_read_b128 a[16:19], v27 offset:16384
    ds_read_b128 a[20:23], v27 offset:17408
    ds_read_b128 a[32:35], v27 offset:20480
    ds_read_b128 a[36:39], v27 offset:21504
    ds_read_b128 a[40:43], v27 offset:22528
    ds_read_b128 a[44:47], v27 offset:23552
    v_cvt_pk_bf16_f32 v40, v64, v65
    v_cvt_pk_bf16_f32 v41, v66, v67
    v_cvt_pk_bf16_f32 v18, v72, v73
    v_cvt_pk_bf16_f32 v19, v74, v75
    v_cvt_pk_bf16_f32 v30, v80, v81
    v_cvt_pk_bf16_f32 v31, v82, v83
    v_cvt_pk_bf16_f32 v44, v68, v69
    v_cvt_pk_bf16_f32 v45, v70, v71
    v_cvt_pk_bf16_f32 v24, v76, v77
    v_cvt_pk_bf16_f32 v25, v78, v79
    v_cvt_pk_bf16_f32 v36, v84, v85
    v_cvt_pk_bf16_f32 v37, v86, v87
    v_cvt_pk_bf16_f32 v42, v88, v89
    v_cvt_pk_bf16_f32 v43, v90, v91
    v_cvt_pk_bf16_f32 v20, v96, v97
    v_cvt_pk_bf16_f32 v21, v98, v99
    v_cvt_pk_bf16_f32 v32, v104, v105
    v_cvt_pk_bf16_f32 v33, v106, v107
    v_cvt_pk_bf16_f32 v46, v92, v93
    v_cvt_pk_bf16_f32 v47, v94, v95
    v_cvt_pk_bf16_f32 v26, v100, v101
    v_cvt_pk_bf16_f32 v27, v102, v103
    v_cvt_pk_bf16_f32 v38, v108, v109
    v_cvt_pk_bf16_f32 v39, v110, v111
    s_waitcnt lgkmcnt(0)
    v_mfma_f32_16x16x32_bf16 v[112:115], a[8:11], v[216:219], v[112:115]
    v_mfma_f32_16x16x32_bf16 v[116:119], a[12:15], v[216:219], v[116:119]
    v_mfma_f32_16x16x32_bf16 v[120:123], v[216:219], a[16:19], v[120:123]
    v_mfma_f32_16x16x32_bf16 v[124:127], v[216:219], a[20:23], v[124:127]
    v_mfma_f32_16x16x32_bf16 v[112:115], a[32:35], v[220:223], v[112:115]
    v_mfma_f32_16x16x32_bf16 v[116:119], a[36:39], v[220:223], v[116:119]
    v_mfma_f32_16x16x32_bf16 v[120:123], v[220:223], a[40:43], v[120:123]
    v_mfma_f32_16x16x32_bf16 v[124:127], v[220:223], a[44:47], v[124:127]
    v_lshlrev_b32 v52, 3, v1
    s_lshl_b32 s6, s3, 11
    s_add_u32 s6, s6, 151552
    v_add_u32 v53, s6, v52
    s_add_u32 s6, s3, 1
    s_and_b32 s6, s6, 3
    s_lshl_b32 s6, s6, 11
    s_add_u32 s6, s6, 151552
    v_add_u32 v55, s6, v52
    ds_write_b64 v55, v[20:21]
    ds_write_b64 v55, v[26:27] offset:512
    ds_write_b64 v55, v[32:33] offset:1024
    ds_write_b64 v55, v[38:39] offset:1536
    v_accvgpr_read_b32 v64, a240
    v_accvgpr_read_b32 v65, a241
    v_accvgpr_read_b32 v66, a242
    v_accvgpr_read_b32 v67, a243
    v_accvgpr_read_b32 v68, a244
    v_accvgpr_read_b32 v69, a245
    v_accvgpr_read_b32 v70, a246
    v_accvgpr_read_b32 v71, a247
    v_accvgpr_read_b32 v72, a248
    v_accvgpr_read_b32 v73, a249
    v_accvgpr_read_b32 v74, a250
    v_accvgpr_read_b32 v75, a251
    v_add_u32 v54, s70, v4
    s_barrier
    s_cmp_eq_u32 s3, 0
    s_cselect_b32 s6, s64, 0x7f000000
    s_mov_b64 exec, 1
    v_mov_b32 v5, 1
    v_mov_b32 v6, 512
    buffer_atomic_add v5, v6, s[48:51], s6 offen
    s_mov_b64 exec, -1
    ds_write_b128 v54, v[112:115] offset:32768
    ds_write_b128 v54, v[116:119] offset:33792
    ds_write_b128 v54, v[120:123] offset:34816
    ds_write_b128 v54, v[124:127] offset:35840
    s_mov_b32 s6, 0x3eb8aa3b
    v_and_b32 v77, 1, v3
    v_lshlrev_b32 v77, 9, v77
    v_lshrrev_b32 v78, 1, v3
    v_lshl_add_u32 v77, v78, 8, v77
    v_lshl_add_u32 v77, v2, 4, v77
    s_add_u32 m0, s76, 49152
    s_nop 0
    buffer_load_dwordx4 v12, s[48:51], s24 offen sc1 lds
    s_lshl_b32 s34, s69, 14
    s_lshl_b32 s35, s5, 10
    s_add_u32 s34, s34, s35
    s_add_u32 s34, s34, 4194304
    s_add_u32 s35, s34, 16384
    s_waitcnt lgkmcnt(0)
    s_add_u32 m0, s76, 53248
    s_nop 0
    buffer_load_dwordx4 v12, s[48:51], s25 offen sc1 lds
    s_barrier
    s_cmp_eq_u32 s3, 0
    s_nop 1
    s_cbranch_scc1 A0_15
    ds_read_b64 v[16:17], v53
    ds_read_b64 v[22:23], v53 offset:512
    ds_read_b64 v[28:29], v53 offset:1024
    ds_read_b64 v[34:35], v53 offset:1536
    s_waitcnt lgkmcnt(0)
    s_nop 1
    s_branch AJ_16
    s_nop 1
A0_15:
    ds_read_b128 v[144:147], v54 offset:36864
    ds_read_b128 v[148:151], v54 offset:37888
    ds_read_b128 v[152:155], v54 offset:38912
    ds_read_b128 v[156:159], v54 offset:39936
    ds_read_b128 v[160:163], v54 offset:40960
    ds_read_b128 v[164:167], v54 offset:41984
    ds_read_b128 v[168:171], v54 offset:43008
    ds_read_b128 v[172:175], v54 offset:44032
    ds_read_b128 v[176:179], v54 offset:45056
    ds_read_b128 v[180:183], v54 offset:46080
    ds_read_b128 v[184:187], v54 offset:47104
    ds_read_b128 v[188:191], v54 offset:48128
    s_waitcnt lgkmcnt(0)
    v_add_f32 v112, v112, v144
    v_add_f32 v160, v160, v176
    v_add_f32 v113, v113, v145
    v_add_f32 v161, v161, v177
    v_add_f32 v114, v114, v146
    v_add_f32 v162, v162, v178
    v_add_f32 v115, v115, v147
    v_add_f32 v163, v163, v179
    v_add_f32 v116, v116, v148
    v_add_f32 v164, v164, v180
    v_add_f32 v117, v117, v149
    v_add_f32 v165, v165, v181
    v_add_f32 v118, v118, v150
    v_add_f32 v166, v166, v182
    v_add_f32 v119, v119, v151
    v_add_f32 v167, v167, v183
    v_add_f32 v120, v120, v152
    v_add_f32 v168, v168, v184
    v_add_f32 v121, v121, v153
    v_add_f32 v169, v169, v185
    v_add_f32 v122, v122, v154
    v_add_f32 v170, v170, v186
    v_add_f32 v123, v123, v155
    v_add_f32 v171, v171, v187
    v_add_f32 v124, v124, v156
    v_add_f32 v172, v172, v188
    v_add_f32 v125, v125, v157
    v_add_f32 v173, v173, v189
    v_add_f32 v126, v126, v158
    v_add_f32 v174, v174, v190
    v_add_f32 v127, v127, v159
    v_add_f32 v175, v175, v191
    v_add_f32 v112, v112, v160
    v_add_f32 v113, v113, v161
    v_add_f32 v114, v114, v162
    v_add_f32 v115, v115, v163
    v_add_f32 v116, v116, v164
    v_add_f32 v117, v117, v165
    v_add_f32 v118, v118, v166
    v_add_f32 v119, v119, v167
    v_add_f32 v120, v120, v168
    v_add_f32 v121, v121, v169
    v_add_f32 v122, v122, v170
    v_add_f32 v123, v123, v171
    v_add_f32 v124, v124, v172
    v_add_f32 v125, v125, v173
    v_add_f32 v126, v126, v174
    v_add_f32 v127, v127, v175
    v_cvt_pk_bf16_f32 v16, v112, v113
    v_cvt_pk_bf16_f32 v17, v114, v115
    v_cvt_pk_bf16_f32 v22, v116, v117
    v_cvt_pk_bf16_f32 v23, v118, v119
    v_cvt_pk_bf16_f32 v28, v120, v121
    v_cvt_pk_bf16_f32 v29, v122, v123
    v_cvt_pk_bf16_f32 v34, v124, v125
    v_cvt_pk_bf16_f32 v35, v126, v127
    s_nop 4
AJ_16:
    v_mfma_f32_16x16x16_bf16 v[128:131], v[18:19], v[42:43], 0
    v_mfma_f32_16x16x16_bf16 v[132:135], v[20:21], v[42:43], 0
    v_mfma_f32_16x16x16_bf16 v[136:139], v[24:25], v[46:47], 0
    v_mfma_f32_16x16x16_bf16 v[140:143], v[26:27], v[46:47], 0
    v_mfma_f32_16x16x16_bf16 v[144:147], v[16:17], v[40:41], 0
    v_mfma_f32_16x16x16_bf16 v[148:151], v[18:19], v[40:41], 0
    v_mfma_f32_16x16x16_bf16 v[152:155], v[22:23], v[44:45], 0
    v_mfma_f32_16x16x16_bf16 v[156:159], v[24:25], v[44:45], 0
    s_nop 0
    v_fma_f32 v128, v128, s6, v68
    v_fma_f32 v129, v129, s6, v69
    v_fma_f32 v130, v130, s6, v70
    v_fma_f32 v131, v131, s6, v71
    v_fma_f32 v132, v132, s6, v64
    v_fma_f32 v133, v133, s6, v65
    v_fma_f32 v134, v134, s6, v66
    v_fma_f32 v135, v135, s6, v67
    v_fma_f32 v136, v136, s6, v68
    v_fma_f32 v137, v137, s6, v69
    v_fma_f32 v138, v138, s6, v70
    v_fma_f32 v139, v139, s6, v71
    v_fma_f32 v140, v140, s6, v64
    v_fma_f32 v141, v141, s6, v65
    v_fma_f32 v142, v142, s6, v66
    v_fma_f32 v143, v143, s6, v67
    s_add_u32 m0, s76, 57344
    s_nop 0
    buffer_load_dwordx4 v12, s[48:51], s26 offen sc1 lds
    v_fma_f32 v144, v144, s6, v72
    v_fma_f32 v145, v145, s6, v73
    v_fma_f32 v146, v146, s6, v74
    v_fma_f32 v147, v147, s6, v75
    v_fma_f32 v148, v148, s6, v64
    v_fma_f32 v149, v149, s6, v65
    v_fma_f32 v150, v150, s6, v66
    v_fma_f32 v151, v151, s6, v67
    v_fma_f32 v152, v152, s6, v72
    v_fma_f32 v153, v153, s6, v73
    v_fma_f32 v154, v154, s6, v74
    v_fma_f32 v155, v155, s6, v75
    v_fma_f32 v156, v156, s6, v64
    v_fma_f32 v157, v157, s6, v65
    v_fma_f32 v158, v158, s6, v66
    v_fma_f32 v159, v159, s6, v67
    v_max3_f32 v160, v128, v129, v130
    v_max3_f32 v161, v131, v132, v133
    v_max3_f32 v162, v136, v137, v138
    v_max3_f32 v163, v139, v140, v141
    v_max3_f32 v164, v144, v145, v146
    v_max3_f32 v165, v147, v148, v149
    v_max3_f32 v166, v152, v153, v154
    v_max3_f32 v167, v155, v156, v157
    s_add_u32 m0, s76, 61440
    s_nop 0
    buffer_load_dwordx4 v12, s[48:51], s27 offen sc1 lds
    v_max3_f32 v160, v160, v134, v135
    v_max_f32 v160, v160, v161
    v_max3_f32 v162, v162, v142, v143
    v_max_f32 v162, v162, v163
    v_max3_f32 v164, v164, v150, v151
    v_max_f32 v164, v164, v165
    v_max3_f32 v166, v166, v158, v159
    v_max_f32 v166, v166, v167
    v_mov_b32 v161, v160
    v_mov_b32 v163, v162
    v_mov_b32 v165, v164
    v_mov_b32 v167, v166
    v_permlane32_swap_b32 v160, v161
    v_permlane32_swap_b32 v162, v163
    v_permlane32_swap_b32 v164, v165
    v_permlane32_swap_b32 v166, v167
    v_max_f32 v160, v160, v161
    v_max_f32 v162, v162, v163
    v_max_f32 v164, v164, v165
    v_max_f32 v166, v166, v167
    v_mov_b32 v161, v160
    v_mov_b32 v163, v162
    v_mov_b32 v165, v164
    v_mov_b32 v167, v166
    s_add_u32 m0, s76, 65536
    s_nop 0
    buffer_load_dwordx4 v13, s[48:51], s12 offen sc1 lds
    v_permlane16_swap_b32 v160, v161
    v_permlane16_swap_b32 v162, v163
    v_permlane16_swap_b32 v164, v165
    v_permlane16_swap_b32 v166, v167
    v_max_f32 v160, v160, v161
    v_max_f32 v162, v162, v163
    v_max_f32 v164, v164, v165
    v_max_f32 v166, v166, v167
    v_sub_f32 v128, v128, v160
    v_sub_f32 v129, v129, v160
    v_sub_f32 v130, v130, v160
    v_sub_f32 v131, v131, v160
    v_sub_f32 v132, v132, v160
    v_sub_f32 v133, v133, v160
    v_sub_f32 v134, v134, v160
    v_sub_f32 v135, v135, v160
    v_sub_f32 v136, v136, v162
    v_sub_f32 v137, v137, v162
    v_sub_f32 v138, v138, v162
    v_sub_f32 v139, v139, v162
    v_sub_f32 v140, v140, v162
    v_sub_f32 v141, v141, v162
    v_sub_f32 v142, v142, v162
    v_sub_f32 v143, v143, v162
    s_add_u32 m0, s76, 69632
    s_nop 0
    buffer_load_dwordx4 v13, s[48:51], s13 offen sc1 lds
    v_sub_f32 v144, v144, v164
    v_sub_f32 v145, v145, v164
    v_sub_f32 v146, v146, v164
    v_sub_f32 v147, v147, v164
    v_sub_f32 v148, v148, v164
    v_sub_f32 v149, v149, v164
    v_sub_f32 v150, v150, v164
    v_sub_f32 v151, v151, v164
    v_sub_f32 v152, v152, v166
    v_sub_f32 v153, v153, v166
    v_sub_f32 v154, v154, v166
    v_sub_f32 v155, v155, v166
    v_sub_f32 v156, v156, v166
    v_sub_f32 v157, v157, v166
    v_sub_f32 v158, v158, v166
    v_sub_f32 v159, v159, v166
    v_exp_f32 v128, v128
    v_exp_f32 v129, v129
    v_exp_f32 v130, v130
    v_exp_f32 v131, v131
    v_exp_f32 v132, v132
    v_exp_f32 v133, v133
    v_exp_f32 v134, v134
    v_exp_f32 v135, v135
    s_add_u32 m0, s76, 73728
    s_nop 0
    buffer_load_dwordx4 v13, s[48:51], s14 offen sc1 lds
    v_exp_f32 v136, v136
    v_exp_f32 v137, v137
    v_exp_f32 v138, v138
    v_exp_f32 v139, v139
    v_exp_f32 v140, v140
    v_exp_f32 v141, v141
    v_exp_f32 v142, v142
    v_exp_f32 v143, v143
    v_exp_f32 v144, v144
    v_exp_f32 v145, v145
    v_exp_f32 v146, v146
    v_exp_f32 v147, v147
    v_exp_f32 v148, v148
    v_exp_f32 v149, v149
    v_exp_f32 v150, v150
    v_exp_f32 v151, v151
    v_exp_f32 v152, v152
    v_exp_f32 v153, v153
    v_exp_f32 v154, v154
    v_exp_f32 v155, v155
    v_exp_f32 v156, v156
    v_exp_f32 v157, v157
    v_exp_f32 v158, v158
    v_exp_f32 v159, v159
    s_add_u32 m0, s76, 77824
    s_nop 0
    buffer_load_dwordx4 v13, s[48:51], s15 offen sc1 lds
    v_add_f32 v160, v128, v129
    v_add_f32 v161, v130, v131
    v_add_f32 v168, v132, v133
    v_add_f32 v169, v134, v135
    v_add_f32 v162, v136, v137
    v_add_f32 v163, v138, v139
    v_add_f32 v172, v140, v141
    v_add_f32 v173, v142, v143
    v_add_f32 v164, v144, v145
    v_add_f32 v165, v146, v147
    v_add_f32 v176, v148, v149
    v_add_f32 v177, v150, v151
    v_add_f32 v166, v152, v153
    v_add_f32 v167, v154, v155
    v_add_f32 v180, v156, v157
    v_add_f32 v181, v158, v159
    v_add_f32 v160, v160, v161
    v_add_f32 v168, v168, v169
    v_add_f32 v162, v162, v163
    v_add_f32 v172, v172, v173
    v_add_f32 v164, v164, v165
    v_add_f32 v176, v176, v177
    v_add_f32 v166, v166, v167
    v_add_f32 v180, v180, v181
    s_add_u32 m0, s76, 81920
    s_nop 0
    buffer_load_dwordx4 v13, s[48:51], s16 offen sc1 lds
    v_add_f32 v160, v160, v168
    v_add_f32 v162, v162, v172
    v_add_f32 v164, v164, v176
    v_add_f32 v166, v166, v180
    v_cvt_pk_bf16_f32 v168, v128, v129
    v_cvt_pk_bf16_f32 v169, v130, v131
    v_cvt_pk_bf16_f32 v170, v132, v133
    v_cvt_pk_bf16_f32 v171, v134, v135
    v_cvt_pk_bf16_f32 v172, v136, v137
    v_cvt_pk_bf16_f32 v173, v138, v139
    v_cvt_pk_bf16_f32 v174, v140, v141
    v_cvt_pk_bf16_f32 v175, v142, v143
    v_cvt_pk_bf16_f32 v176, v144, v145
    v_cvt_pk_bf16_f32 v177, v146, v147
    v_cvt_pk_bf16_f32 v178, v148, v149
    v_cvt_pk_bf16_f32 v179, v150, v151
    v_cvt_pk_bf16_f32 v180, v152, v153
    v_cvt_pk_bf16_f32 v181, v154, v155
    v_cvt_pk_bf16_f32 v182, v156, v157
    v_cvt_pk_bf16_f32 v183, v158, v159
    v_mfma_f32_16x16x32_bf16 v[184:187], v[30:33], v[168:171], 0
    v_mfma_f32_16x16x32_bf16 v[188:191], v[36:39], v[172:175], 0
    v_mfma_f32_16x16x32_bf16 v[192:195], v[28:31], v[176:179], 0
    v_mfma_f32_16x16x32_bf16 v[196:199], v[34:37], v[180:183], 0
    s_add_u32 m0, s76, 86016
    s_nop 0
    buffer_load_dwordx4 v13, s[48:51], s17 offen sc1 lds
    v_mov_b32 v161, v160
    v_mov_b32 v163, v162
    v_mov_b32 v165, v164
    v_mov_b32 v167, v166
    v_permlane32_swap_b32 v160, v161
    v_permlane32_swap_b32 v162, v163
    v_permlane32_swap_b32 v164, v165
    v_permlane32_swap_b32 v166, v167
    v_add_f32 v160, v160, v161
    v_add_f32 v162, v162, v163
    v_add_f32 v164, v164, v165
    v_add_f32 v166, v166, v167
    v_mov_b32 v161, v160
    v_mov_b32 v163, v162
    v_mov_b32 v165, v164
    v_mov_b32 v167, v166
    v_permlane16_swap_b32 v160, v161
    v_permlane16_swap_b32 v162, v163
    v_permlane16_swap_b32 v164, v165
    v_permlane16_swap_b32 v166, v167
    v_add_f32 v160, v160, v161
    v_add_f32 v162, v162, v163
    v_add_f32 v164, v164, v165
    v_add_f32 v166, v166, v167
    s_add_u32 m0, s76, 90112
    s_nop 0
    buffer_load_dwordx4 v13, s[48:51], s18 offen sc1 lds
    v_rcp_f32 v160, v160
    v_rcp_f32 v162, v162
    v_rcp_f32 v164, v164
    v_rcp_f32 v166, v166
    v_mul_f32 v184, v184, v160
    v_mul_f32 v185, v185, v160
    v_mul_f32 v186, v186, v160
    v_mul_f32 v187, v187, v160
    v_mul_f32 v188, v188, v162
    v_mul_f32 v189, v189, v162
    v_mul_f32 v190, v190, v162
    v_mul_f32 v191, v191, v162
    v_mul_f32 v192, v192, v164
    v_mul_f32 v193, v193, v164
    v_mul_f32 v194, v194, v164
    v_mul_f32 v195, v195, v164
    v_mul_f32 v196, v196, v166
    v_mul_f32 v197, v197, v166
    v_mul_f32 v198, v198, v166
    v_mul_f32 v199, v199, v166
    v_cvt_pk_bf16_f32 v200, v184, v185
    v_cvt_pk_bf16_f32 v201, v186, v187
    v_cvt_pk_bf16_f32 v202, v188, v189
    v_cvt_pk_bf16_f32 v203, v190, v191
    v_cvt_pk_bf16_f32 v204, v192, v193
    v_cvt_pk_bf16_f32 v205, v194, v195
    v_cvt_pk_bf16_f32 v206, v196, v197
    v_cvt_pk_bf16_f32 v207, v198, v199
    v_permlane16_swap_b32 v200, v202
    v_permlane16_swap_b32 v201, v203
    buffer_store_dwordx4 v[200:203], v77, s[48:51], s35 offen sc1
    v_permlane16_swap_b32 v204, v206
    v_permlane16_swap_b32 v205, v207
    buffer_store_dwordx4 v[204:207], v77, s[48:51], s34 offen sc1
    s_waitcnt vmcnt(0)
    s_barrier
    s_cmp_lg_u32 s3, 0
    s_nop 1
    s_cbranch_scc1 SO_17
    s_mov_b64 exec, 1
    v_mov_b32 v5, 1
    v_mov_b32 v6, 128
    buffer_atomic_add v5, v6, s[48:51], s68 offen
    s_mov_b64 exec, -1
    s_mov_b64 exec, 1
    v_mov_b32 v6, 128
    s_mov_b32 s90, 0
    s_nop 3
P_19:
    buffer_load_dword v5, v6, s[48:51], s68 offen sc1
    s_add_u32 s90, s90, 1
    s_cmp_gt_u32 s90, 400000
    s_nop 1
    s_cbranch_scc1 P_20
    s_waitcnt vmcnt(0)
    v_cmp_gt_u32 vcc, 16, v5
    s_nop 4
    s_cbranch_vccnz P_19
    s_nop 1
P_20:
    s_mov_b64 exec, -1
    s_nop 1
    s_branch SE_18
    s_nop 1
SO_17:
SE_18:
    s_barrier
    s_lshr_b32 s6, s66, 4
    s_add_u32 s7, s3, 0
    s_and_b32 s7, s7, 3
    s_add_u32 s7, s7, s6
    s_mul_i32 s7, s7, 16384
    s_add_u32 s7, s7, 4194304
    v_add_u32 v20, s7, v4
    s_add_u32 s7, s3, 1
    s_and_b32 s7, s7, 3
    s_add_u32 s7, s7, s6
    s_mul_i32 s7, s7, 16384
    s_add_u32 s7, s7, 4194304
    v_add_u32 v21, s7, v4
    s_add_u32 s7, s3, 2
    s_and_b32 s7, s7, 3
    s_add_u32 s7, s7, s6
    s_mul_i32 s7, s7, 16384
    s_add_u32 s7, s7, 4194304
    v_add_u32 v22, s7, v4
    s_add_u32 s7, s3, 3
    s_and_b32 s7, s7, 3
    s_add_u32 s7, s7, s6
    s_mul_i32 s7, s7, 16384
    s_add_u32 s7, s7, 4194304
    v_add_u32 v23, s7, v4
    buffer_load_dwordx4 a[0:3], v20, s[48:51], s36 offen sc1
    buffer_load_dwordx4 a[4:7], v21, s[48:51], s36 offen sc1
    buffer_load_dwordx4 a[8:11], v22, s[48:51], s36 offen sc1
    buffer_load_dwordx4 a[12:15], v23, s[48:51], s36 offen sc1
    buffer_load_dwordx4 a[16:19], v20, s[48:51], s37 offen sc1
    buffer_load_dwordx4 a[20:23], v21, s[48:51], s37 offen sc1
    buffer_load_dwordx4 a[24:27], v22, s[48:51], s37 offen sc1
    buffer_load_dwordx4 a[28:31], v23, s[48:51], s37 offen sc1
    buffer_load_dwordx4 a[32:35], v20, s[48:51], s38 offen sc1
    buffer_load_dwordx4 a[36:39], v21, s[48:51], s38 offen sc1
    buffer_load_dwordx4 a[40:43], v22, s[48:51], s38 offen sc1
    buffer_load_dwordx4 a[44:47], v23, s[48:51], s38 offen sc1
    buffer_load_dwordx4 a[48:51], v20, s[48:51], s39 offen sc1
    buffer_load_dwordx4 a[52:55], v21, s[48:51], s39 offen sc1
    buffer_load_dwordx4 a[56:59], v22, s[48:51], s39 offen sc1
    buffer_load_dwordx4 a[60:63], v23, s[48:51], s39 offen sc1
    s_lshl_b32 s34, s3, 4
    s_add_u32 s34, s34, s66
    v_add_u32 v24, s34, v2
    v_lshlrev_b32 v25, 10, v24
    v_lshl_add_u32 v25, v3, 4, v25
    v_add_u32 v16, s70, v4
    s_lshl_b32 s35, s67, 1
    buffer_load_dwordx4 v[160:163], v25, s[8:11], s35 offen
    buffer_load_dwordx4 v[164:167], v25, s[8:11], s35 offen offset:64
    s_waitcnt vmcnt(14)
    v_mfma_f32_16x16x32_bf16 v[64:67], a[64:67], a[0:3], 0
    v_mfma_f32_16x16x32_bf16 v[68:71], a[68:71], a[0:3], 0
    s_add_u32 m0, s76, 94208
    s_nop 0
    buffer_load_dwordx4 v13, s[48:51], s19 offen sc1 lds
    v_mfma_f32_16x16x32_bf16 v[72:75], a[72:75], a[0:3], 0
    v_mfma_f32_16x16x32_bf16 v[76:79], a[76:79], a[0:3], 0
    v_mfma_f32_16x16x32_bf16 v[80:83], a[64:67], a[4:7], 0
    v_mfma_f32_16x16x32_bf16 v[84:87], a[68:71], a[4:7], 0
    v_mfma_f32_16x16x32_bf16 v[88:91], a[72:75], a[4:7], 0
    v_mfma_f32_16x16x32_bf16 v[92:95], a[76:79], a[4:7], 0
    v_mfma_f32_16x16x32_bf16 v[96:99], a[64:67], a[8:11], 0
    v_mfma_f32_16x16x32_bf16 v[100:103], a[68:71], a[8:11], 0
    v_mfma_f32_16x16x32_bf16 v[104:107], a[72:75], a[8:11], 0
    v_mfma_f32_16x16x32_bf16 v[108:111], a[76:79], a[8:11], 0
    v_mfma_f32_16x16x32_bf16 v[112:115], a[64:67], a[12:15], 0
    v_mfma_f32_16x16x32_bf16 v[116:119], a[68:71], a[12:15], 0
    v_mfma_f32_16x16x32_bf16 v[120:123], a[72:75], a[12:15], 0
    v_mfma_f32_16x16x32_bf16 v[124:127], a[76:79], a[12:15], 0
    s_waitcnt vmcnt(11)
    v_mfma_f32_16x16x32_bf16 v[64:67], a[80:83], a[16:19], v[64:67]
    v_mfma_f32_16x16x32_bf16 v[68:71], a[84:87], a[16:19], v[68:71]
    v_mfma_f32_16x16x32_bf16 v[72:75], a[88:91], a[16:19], v[72:75]
    v_mfma_f32_16x16x32_bf16 v[76:79], a[92:95], a[16:19], v[76:79]
    v_mfma_f32_16x16x32_bf16 v[80:83], a[80:83], a[20:23], v[80:83]
    v_mfma_f32_16x16x32_bf16 v[84:87], a[84:87], a[20:23], v[84:87]
    v_mfma_f32_16x16x32_bf16 v[88:91], a[88:91], a[20:23], v[88:91]
    v_mfma_f32_16x16x32_bf16 v[92:95], a[92:95], a[20:23], v[92:95]
    v_mfma_f32_16x16x32_bf16 v[96:99], a[80:83], a[24:27], v[96:99]
    v_mfma_f32_16x16x32_bf16 v[100:103], a[84:87], a[24:27], v[100:103]
    v_mfma_f32_16x16x32_bf16 v[104:107], a[88:91], a[24:27], v[104:107]
    v_mfma_f32_16x16x32_bf16 v[108:111], a[92:95], a[24:27], v[108:111]
    v_mfma_f32_16x16x32_bf16 v[112:115], a[80:83], a[28:31], v[112:115]
    v_mfma_f32_16x16x32_bf16 v[116:119], a[84:87], a[28:31], v[116:119]
    v_mfma_f32_16x16x32_bf16 v[120:123], a[88:91], a[28:31], v[120:123]
    v_mfma_f32_16x16x32_bf16 v[124:127], a[92:95], a[28:31], v[124:127]
    s_waitcnt vmcnt(7)
    v_mfma_f32_16x16x32_bf16 v[64:67], a[96:99], a[32:35], v[64:67]
    v_mfma_f32_16x16x32_bf16 v[68:71], a[100:103], a[32:35], v[68:71]
    v_mfma_f32_16x16x32_bf16 v[72:75], a[104:107], a[32:35], v[72:75]
    v_mfma_f32_16x16x32_bf16 v[76:79], a[108:111], a[32:35], v[76:79]
    v_mfma_f32_16x16x32_bf16 v[80:83], a[96:99], a[36:39], v[80:83]
    v_mfma_f32_16x16x32_bf16 v[84:87], a[100:103], a[36:39], v[84:87]
    v_mfma_f32_16x16x32_bf16 v[88:91], a[104:107], a[36:39], v[88:91]
    v_mfma_f32_16x16x32_bf16 v[92:95], a[108:111], a[36:39], v[92:95]
    v_mfma_f32_16x16x32_bf16 v[96:99], a[96:99], a[40:43], v[96:99]
    v_mfma_f32_16x16x32_bf16 v[100:103], a[100:103], a[40:43], v[100:103]
    v_mfma_f32_16x16x32_bf16 v[104:107], a[104:107], a[40:43], v[104:107]
    v_mfma_f32_16x16x32_bf16 v[108:111], a[108:111], a[40:43], v[108:111]
    v_mfma_f32_16x16x32_bf16 v[112:115], a[96:99], a[44:47], v[112:115]
    v_mfma_f32_16x16x32_bf16 v[116:119], a[100:103], a[44:47], v[116:119]
    v_mfma_f32_16x16x32_bf16 v[120:123], a[104:107], a[44:47], v[120:123]
    v_mfma_f32_16x16x32_bf16 v[124:127], a[108:111], a[44:47], v[124:127]
    s_waitcnt vmcnt(3)
    v_mfma_f32_16x16x32_bf16 v[64:67], a[112:115], a[48:51], v[64:67]
    v_mfma_f32_16x16x32_bf16 v[68:71], a[116:119], a[48:51], v[68:71]
    v_mfma_f32_16x16x32_bf16 v[72:75], a[120:123], a[48:51], v[72:75]
    v_mfma_f32_16x16x32_bf16 v[76:79], a[124:127], a[48:51], v[76:79]
    v_mfma_f32_16x16x32_bf16 v[80:83], a[112:115], a[52:55], v[80:83]
    v_mfma_f32_16x16x32_bf16 v[84:87], a[116:119], a[52:55], v[84:87]
    v_mfma_f32_16x16x32_bf16 v[88:91], a[120:123], a[52:55], v[88:91]
    v_mfma_f32_16x16x32_bf16 v[92:95], a[124:127], a[52:55], v[92:95]
    v_mfma_f32_16x16x32_bf16 v[96:99], a[112:115], a[56:59], v[96:99]
    v_mfma_f32_16x16x32_bf16 v[100:103], a[116:119], a[56:59], v[100:103]
    v_mfma_f32_16x16x32_bf16 v[104:107], a[120:123], a[56:59], v[104:107]
    v_mfma_f32_16x16x32_bf16 v[108:111], a[124:127], a[56:59], v[108:111]
    v_mfma_f32_16x16x32_bf16 v[112:115], a[112:115], a[60:63], v[112:115]
    v_mfma_f32_16x16x32_bf16 v[116:119], a[116:119], a[60:63], v[116:119]
    v_mfma_f32_16x16x32_bf16 v[120:123], a[120:123], a[60:63], v[120:123]
    v_mfma_f32_16x16x32_bf16 v[124:127], a[124:127], a[60:63], v[124:127]
    s_add_u32 s7, s3, 1
    s_and_b32 s7, s7, 3
    s_lshl_b32 s7, s7, 12
    s_add_u32 s7, s7, 0
    v_add_u32 v27, s7, v4
    s_add_u32 s7, s3, 2
    s_and_b32 s7, s7, 3
    s_lshl_b32 s7, s7, 12
    s_add_u32 s7, s7, 16384
    v_add_u32 v28, s7, v4
    s_add_u32 s7, s3, 3
    s_and_b32 s7, s7, 3
    s_lshl_b32 s7, s7, 12
    s_add_u32 s7, s7, 32768
    v_add_u32 v29, s7, v4
    v_lshlrev_b32 v22, 5, v3
    v_add_u32 v22, 161536, v22
    ds_read_b128 v[168:171], v22 offset:0
    ds_read_b128 v[172:175], v22 offset:16
    ds_read_b128 v[176:179], v22 offset:128
    ds_read_b128 v[180:183], v22 offset:144
    ds_read_b128 v[208:211], v22 offset:512
    ds_read_b128 v[212:215], v22 offset:528
    ds_read_b128 v[216:219], v22 offset:640
    ds_read_b128 v[220:223], v22 offset:656
    ds_write_b128 v27, v[80:83] offset:0
    ds_write_b128 v27, v[84:87] offset:1024
    ds_write_b128 v27, v[88:91] offset:2048
    ds_write_b128 v27, v[92:95] offset:3072
    ds_write_b128 v28, v[96:99] offset:0
    ds_write_b128 v28, v[100:103] offset:1024
    ds_write_b128 v28, v[104:107] offset:2048
    ds_write_b128 v28, v[108:111] offset:3072
    ds_write_b128 v29, v[112:115] offset:0
    ds_write_b128 v29, v[116:119] offset:1024
    ds_write_b128 v29, v[120:123] offset:2048
    ds_write_b128 v29, v[124:127] offset:3072
    s_waitcnt vmcnt(1)
    v_lshlrev_b32 v192, 16, v160
    v_and_b32 v193, 0xffff0000, v160
    v_lshlrev_b32 v194, 16, v161
    v_and_b32 v195, 0xffff0000, v161
    v_lshlrev_b32 v196, 16, v162
    v_and_b32 v197, 0xffff0000, v162
    v_lshlrev_b32 v198, 16, v163
    v_and_b32 v199, 0xffff0000, v163
    v_lshlrev_b32 v200, 16, v164
    v_and_b32 v201, 0xffff0000, v164
    v_lshlrev_b32 v202, 16, v165
    v_and_b32 v203, 0xffff0000, v165
    v_lshlrev_b32 v204, 16, v166
    v_and_b32 v205, 0xffff0000, v166
    v_lshlrev_b32 v206, 16, v167
    v_and_b32 v207, 0xffff0000, v167
    s_lshr_b32 s34, s66, 4
    s_add_u32 s34, s34, s3
    s_lshl_b32 s34, s34, 14
    s_lshl_b32 s35, s67, 5
    s_add_u32 s34, s34, s35
    s_add_u32 s34, s34, 7340032
    v_add_u32 v26, 0, v16
    s_waitcnt lgkmcnt(0)
    s_barrier
    ds_read_b128 v[80:83], v26 offset:0
    ds_read_b128 v[84:87], v26 offset:1024
    ds_read_b128 v[88:91], v26 offset:2048
    ds_read_b128 v[92:95], v26 offset:3072
    ds_read_b128 v[96:99], v26 offset:16384
    ds_read_b128 v[100:103], v26 offset:17408
    ds_read_b128 v[104:107], v26 offset:18432
    ds_read_b128 v[108:111], v26 offset:19456
    ds_read_b128 v[112:115], v26 offset:32768
    ds_read_b128 v[116:119], v26 offset:33792
    ds_read_b128 v[120:123], v26 offset:34816
    ds_read_b128 v[124:127], v26 offset:35840
    s_waitcnt lgkmcnt(8)
    v_add_f32 v64, v64, v80
    v_add_f32 v65, v65, v81
    v_add_f32 v66, v66, v82
    v_add_f32 v67, v67, v83
    v_add_f32 v68, v68, v84
    v_add_f32 v69, v69, v85
    v_add_f32 v70, v70, v86
    v_add_f32 v71, v71, v87
    v_add_f32 v72, v72, v88
    v_add_f32 v73, v73, v89
    v_add_f32 v74, v74, v90
    v_add_f32 v75, v75, v91
    v_add_f32 v76, v76, v92
    v_add_f32 v77, v77, v93
    v_add_f32 v78, v78, v94
    v_add_f32 v79, v79, v95
    s_waitcnt lgkmcnt(0)
    v_add_f32 v96, v96, v112
    v_add_f32 v97, v97, v113
    v_add_f32 v98, v98, v114
    v_add_f32 v99, v99, v115
    v_add_f32 v100, v100, v116
    v_add_f32 v101, v101, v117
    v_add_f32 v102, v102, v118
    v_add_f32 v103, v103, v119
    v_add_f32 v104, v104, v120
    v_add_f32 v105, v105, v121
    v_add_f32 v106, v106, v122
    v_add_f32 v107, v107, v123
    v_add_f32 v108, v108, v124
    v_add_f32 v109, v109, v125
    v_add_f32 v110, v110, v126
    v_add_f32 v111, v111, v127
    v_add_f32 v64, v64, v96
    v_add_f32 v65, v65, v97
    v_add_f32 v66, v66, v98
    v_add_f32 v67, v67, v99
    v_add_f32 v68, v68, v100
    v_add_f32 v69, v69, v101
    v_add_f32 v70, v70, v102
    v_add_f32 v71, v71, v103
    v_add_f32 v72, v72, v104
    v_add_f32 v73, v73, v105
    v_add_f32 v74, v74, v106
    v_add_f32 v75, v75, v107
    v_add_f32 v76, v76, v108
    v_add_f32 v77, v77, v109
    v_add_f32 v78, v78, v110
    v_add_f32 v79, v79, v111
    v_fma_f32 v64, v64, v168, v192
    v_fma_f32 v65, v65, v169, v193
    v_fma_f32 v66, v66, v170, v194
    v_fma_f32 v67, v67, v171, v195
    v_fma_f32 v68, v68, v172, v196
    v_fma_f32 v69, v69, v173, v197
    v_fma_f32 v70, v70, v174, v198
    v_fma_f32 v71, v71, v175, v199
    v_fma_f32 v72, v72, v176, v200
    v_fma_f32 v73, v73, v177, v201
    v_fma_f32 v74, v74, v178, v202
    v_fma_f32 v75, v75, v179, v203
    v_fma_f32 v76, v76, v180, v204
    v_fma_f32 v77, v77, v181, v205
    v_fma_f32 v78, v78, v182, v206
    v_fma_f32 v79, v79, v183, v207
    v_mul_f32 v208, v64, v208
    v_mul_f32 v209, v65, v209
    v_mul_f32 v210, v66, v210
    v_mul_f32 v211, v67, v211
    v_mul_f32 v212, v68, v212
    v_mul_f32 v213, v69, v213
    v_mul_f32 v214, v70, v214
    v_mul_f32 v215, v71, v215
    v_mul_f32 v216, v72, v216
    v_mul_f32 v217, v73, v217
    v_mul_f32 v218, v74, v218
    v_mul_f32 v219, v75, v219
    v_mul_f32 v220, v76, v220
    v_mul_f32 v221, v77, v221
    v_mul_f32 v222, v78, v222
    v_mul_f32 v223, v79, v223
    v_cvt_pk_bf16_f32 v224, v208, v209
    v_cvt_pk_bf16_f32 v225, v210, v211
    v_cvt_pk_bf16_f32 v226, v212, v213
    v_cvt_pk_bf16_f32 v227, v214, v215
    v_cvt_pk_bf16_f32 v228, v216, v217
    v_cvt_pk_bf16_f32 v229, v218, v219
    v_cvt_pk_bf16_f32 v230, v220, v221
    v_cvt_pk_bf16_f32 v231, v222, v223
    buffer_store_dwordx4 v[224:227], v4, s[48:51], s34 offen sc1
    buffer_store_dwordx4 v[228:231], v4, s[48:51], s34 offen offset:1024 sc1
    v_cvt_pk_bf16_f32 v184, v64, v65
    v_cvt_pk_bf16_f32 v185, v66, v67
    v_cvt_pk_bf16_f32 v186, v68, v69
    v_cvt_pk_bf16_f32 v187, v70, v71
    v_cvt_pk_bf16_f32 v188, v72, v73
    v_cvt_pk_bf16_f32 v189, v74, v75
    v_cvt_pk_bf16_f32 v190, v76, v77
    v_cvt_pk_bf16_f32 v191, v78, v79
    v_add_f32 v96, v64, v72
    v_add_f32 v97, v65, v73
    v_add_f32 v98, v66, v74
    v_add_f32 v99, v67, v75
    v_add_f32 v100, v68, v76
    v_add_f32 v101, v69, v77
    v_add_f32 v102, v70, v78
    v_add_f32 v103, v71, v79
    v_add_f32 v96, v96, v100
    v_add_f32 v97, v97, v101
    v_add_f32 v98, v98, v102
    v_add_f32 v99, v99, v103
    v_add_f32 v96, v96, v98
    v_add_f32 v97, v97, v99
    v_add_f32 v96, v96, v97
    v_mov_b32 v28, v96
    s_nop 1
    v_permlane32_swap_b32 v96, v28
    v_add_f32 v96, v96, v28
    v_mov_b32 v28, v96
    s_nop 1
    v_permlane16_swap_b32 v96, v28
    v_add_f32 v96, v96, v28
    v_mul_f32 v26, 0x3c800000, v96
    v_sub_f32 v64, v64, v26
    v_sub_f32 v65, v65, v26
    v_sub_f32 v66, v66, v26
    v_sub_f32 v67, v67, v26
    v_sub_f32 v68, v68, v26
    v_sub_f32 v69, v69, v26
    v_sub_f32 v70, v70, v26
    v_sub_f32 v71, v71, v26
    v_sub_f32 v72, v72, v26
    v_sub_f32 v73, v73, v26
    v_sub_f32 v74, v74, v26
    v_sub_f32 v75, v75, v26
    v_sub_f32 v76, v76, v26
    v_sub_f32 v77, v77, v26
    v_sub_f32 v78, v78, v26
    v_sub_f32 v79, v79, v26
    v_mul_f32 v96, v64, v64
    v_mul_f32 v97, v65, v65
    v_mul_f32 v98, v66, v66
    v_mul_f32 v99, v67, v67
    v_fmac_f32 v96, v68, v68
    v_fmac_f32 v97, v69, v69
    v_fmac_f32 v98, v70, v70
    v_fmac_f32 v99, v71, v71
    v_fmac_f32 v96, v72, v72
    v_fmac_f32 v97, v73, v73
    v_fmac_f32 v98, v74, v74
    v_fmac_f32 v99, v75, v75
    v_fmac_f32 v96, v76, v76
    v_fmac_f32 v97, v77, v77
    v_fmac_f32 v98, v78, v78
    v_fmac_f32 v99, v79, v79
    v_add_f32 v96, v96, v97
    v_add_f32 v98, v98, v99
    v_add_f32 v27, v96, v98
    v_mov_b32 v28, v27
    s_nop 1
    v_permlane32_swap_b32 v27, v28
    v_add_f32 v27, v27, v28
    v_mov_b32 v28, v27
    s_nop 1
    v_permlane16_swap_b32 v27, v28
    v_add_f32 v27, v27, v28
    v_lshlrev_b32 v28, 3, v24
    s_lshl_b32 s35, s71, 14
    s_add_u32 s35, s35, 10485760
    s_mov_b64 exec, 0xffff
    buffer_store_dwordx2 v[26:27], v28, s[48:51], s35 offen sc1
    s_mov_b64 exec, -1
    v_accvgpr_write_b32 a240, v184
    v_accvgpr_write_b32 a241, v185
    v_accvgpr_write_b32 a242, v186
    v_accvgpr_write_b32 a243, v187
    v_accvgpr_write_b32 a244, v188
    v_accvgpr_write_b32 a245, v189
    v_accvgpr_write_b32 a246, v190
    v_accvgpr_write_b32 a247, v191
    s_waitcnt vmcnt(0)
    s_barrier
    s_cmp_lg_u32 s3, 0
    s_nop 1
    s_cbranch_scc1 SO_21
    s_mov_b64 exec, 1
    v_mov_b32 v5, 1
    v_mov_b32 v6, 256
    buffer_atomic_add v5, v6, s[48:51], s68 offen
    s_mov_b64 exec, -1
    s_mov_b64 exec, 1
    v_mov_b32 v6, 256
    s_mov_b32 s90, 0
    s_nop 3
P_23:
    buffer_load_dword v5, v6, s[48:51], s68 offen sc1
    s_add_u32 s90, s90, 1
    s_cmp_gt_u32 s90, 400000
    s_nop 1
    s_cbranch_scc1 P_24
    s_waitcnt vmcnt(0)
    v_cmp_gt_u32 vcc, 16, v5
    s_nop 4
    s_cbranch_vccnz P_23
    s_nop 1
P_24:
    s_mov_b64 exec, -1
    s_nop 1
    s_branch SE_22
    s_nop 1
SO_21:
    s_cmp_lg_u32 s3, 1
    s_nop 1
    s_cbranch_scc1 SJ_25
    s_mov_b64 exec, 1
    v_mov_b32 v6, 512
    s_mov_b32 s90, 0
    s_nop 3
P_26:
    buffer_load_dword v5, v6, s[48:51], s64 offen sc1
    s_add_u32 s90, s90, 1
    s_cmp_gt_u32 s90, 400000
    s_nop 1
    s_cbranch_scc1 P_27
    s_waitcnt vmcnt(0)
    v_cmp_gt_u32 vcc, 16, v5
    s_nop 4
    s_cbranch_vccnz P_26
    s_nop 1
P_27:
    s_mov_b64 exec, -1
    s_mul_i32 s34, s5, 24576
    s_add_u32 s34, s34, 20971520
    s_add_u32 s35, s34, 0
    buffer_load_dwordx4 v[128:131], v4, s[48:51], s35 offen sc1
    s_add_u32 s35, s34, 1536
    buffer_load_dwordx4 v[132:135], v4, s[48:51], s35 offen sc1
    s_add_u32 s35, s34, 3072
    buffer_load_dwordx4 v[136:139], v4, s[48:51], s35 offen sc1
    s_add_u32 s35, s34, 4608
    buffer_load_dwordx4 v[140:143], v4, s[48:51], s35 offen sc1
    s_add_u32 s35, s34, 6144
    buffer_load_dwordx4 v[144:147], v4, s[48:51], s35 offen sc1
    s_add_u32 s35, s34, 7680
    buffer_load_dwordx4 v[148:151], v4, s[48:51], s35 offen sc1
    s_add_u32 s35, s34, 9216
    buffer_load_dwordx4 v[152:155], v4, s[48:51], s35 offen sc1
    s_add_u32 s35, s34, 10752
    buffer_load_dwordx4 v[156:159], v4, s[48:51], s35 offen sc1
    s_add_u32 s35, s34, 12288
    buffer_load_dwordx4 v[160:163], v4, s[48:51], s35 offen sc1
    s_add_u32 s35, s34, 13824
    buffer_load_dwordx4 v[164:167], v4, s[48:51], s35 offen sc1
    s_add_u32 s35, s34, 15360
    buffer_load_dwordx4 v[168:171], v4, s[48:51], s35 offen sc1
    s_add_u32 s35, s34, 16896
    buffer_load_dwordx4 v[172:175], v4, s[48:51], s35 offen sc1
    s_add_u32 s35, s34, 18432
    buffer_load_dwordx4 v[176:179], v4, s[48:51], s35 offen sc1
    s_add_u32 s35, s34, 19968
    buffer_load_dwordx4 v[180:183], v4, s[48:51], s35 offen sc1
    s_add_u32 s35, s34, 21504
    buffer_load_dwordx4 v[184:187], v4, s[48:51], s35 offen sc1
    s_add_u32 s35, s34, 23040
    buffer_load_dwordx4 v[188:191], v4, s[48:51], s35 offen sc1
    s_waitcnt vmcnt(0)
    v_add_f32 v128, v128, v160
    v_add_f32 v129, v129, v161
    v_add_f32 v130, v130, v162
    v_add_f32 v131, v131, v163
    v_add_f32 v132, v132, v164
    v_add_f32 v133, v133, v165
    v_add_f32 v134, v134, v166
    v_add_f32 v135, v135, v167
    v_add_f32 v136, v136, v168
    v_add_f32 v137, v137, v169
    v_add_f32 v138, v138, v170
    v_add_f32 v139, v139, v171
    v_add_f32 v140, v140, v172
    v_add_f32 v141, v141, v173
    v_add_f32 v142, v142, v174
    v_add_f32 v143, v143, v175
    v_add_f32 v144, v144, v176
    v_add_f32 v145, v145, v177
    v_add_f32 v146, v146, v178
    v_add_f32 v147, v147, v179
    v_add_f32 v148, v148, v180
    v_add_f32 v149, v149, v181
    v_add_f32 v150, v150, v182
    v_add_f32 v151, v151, v183
    v_add_f32 v152, v152, v184
    v_add_f32 v153, v153, v185
    v_add_f32 v154, v154, v186
    v_add_f32 v155, v155, v187
    v_add_f32 v156, v156, v188
    v_add_f32 v157, v157, v189
    v_add_f32 v158, v158, v190
    v_add_f32 v159, v159, v191
    v_add_f32 v128, v128, v144
    v_add_f32 v129, v129, v145
    v_add_f32 v130, v130, v146
    v_add_f32 v131, v131, v147
    v_add_f32 v132, v132, v148
    v_add_f32 v133, v133, v149
    v_add_f32 v134, v134, v150
    v_add_f32 v135, v135, v151
    v_add_f32 v136, v136, v152
    v_add_f32 v137, v137, v153
    v_add_f32 v138, v138, v154
    v_add_f32 v139, v139, v155
    v_add_f32 v140, v140, v156
    v_add_f32 v141, v141, v157
    v_add_f32 v142, v142, v158
    v_add_f32 v143, v143, v159
    v_add_f32 v128, v128, v136
    v_add_f32 v129, v129, v137
    v_add_f32 v130, v130, v138
    v_add_f32 v131, v131, v139
    v_add_f32 v132, v132, v140
    v_add_f32 v133, v133, v141
    v_add_f32 v134, v134, v142
    v_add_f32 v135, v135, v143
    v_add_f32 v128, v128, v132
    v_add_f32 v129, v129, v133
    v_add_f32 v130, v130, v134
    v_add_f32 v131, v131, v135
    v_add_u32 v5, 0, v1
    v_mov_b32 v6, 1.0
    v_mov_b32 v132, 0xbfb8aa3b
    v_mov_b32 v133, 0xbf317218
    v_subrev_u32 v134, 24, v5
    v_cmp_gt_u32 vcc, 24, v134
    s_nop 1
    v_cndmask_b32 v6, v6, v132, vcc
    v_cmp_lt_u32 vcc, 71, v5
    s_nop 1
    v_cndmask_b32 v6, v6, v133, vcc
    v_mul_f32 v128, v128, v6
    v_mul_f32 v129, v129, v6
    v_mul_f32 v130, v130, v6
    v_mul_f32 v131, v131, v6
    v_add_u32 v5, 160000, v4
    ds_write_b128 v5, v[128:131]
    s_mov_b64 exec, -1
    s_waitcnt lgkmcnt(0)
    s_nop 1
SJ_25:
    s_cmp_lg_u32 s3, 2
    s_nop 1
    s_cbranch_scc1 SJ_28
    s_mov_b64 exec, 1
    v_mov_b32 v6, 512
    s_mov_b32 s90, 0
    s_nop 3
P_29:
    buffer_load_dword v5, v6, s[48:51], s64 offen sc1
    s_add_u32 s90, s90, 1
    s_cmp_gt_u32 s90, 400000
    s_nop 1
    s_cbranch_scc1 P_30
    s_waitcnt vmcnt(0)
    v_cmp_gt_u32 vcc, 16, v5
    s_nop 4
    s_cbranch_vccnz P_29
    s_nop 1
P_30:
    s_mov_b64 exec, -1
    s_mul_i32 s34, s5, 24576
    s_add_u32 s34, s34, 20972544
    s_mov_b32 exec_lo, -1
    s_mov_b32 exec_hi, 0
    s_add_u32 s35, s34, 0
    buffer_load_dwordx4 v[128:131], v4, s[48:51], s35 offen sc1
    s_add_u32 s35, s34, 1536
    buffer_load_dwordx4 v[132:135], v4, s[48:51], s35 offen sc1
    s_add_u32 s35, s34, 3072
    buffer_load_dwordx4 v[136:139], v4, s[48:51], s35 offen sc1
    s_add_u32 s35, s34, 4608
    buffer_load_dwordx4 v[140:143], v4, s[48:51], s35 offen sc1
    s_add_u32 s35, s34, 6144
    buffer_load_dwordx4 v[144:147], v4, s[48:51], s35 offen sc1
    s_add_u32 s35, s34, 7680
    buffer_load_dwordx4 v[148:151], v4, s[48:51], s35 offen sc1
    s_add_u32 s35, s34, 9216
    buffer_load_dwordx4 v[152:155], v4, s[48:51], s35 offen sc1
    s_add_u32 s35, s34, 10752
    buffer_load_dwordx4 v[156:159], v4, s[48:51], s35 offen sc1
    s_add_u32 s35, s34, 12288
    buffer_load_dwordx4 v[160:163], v4, s[48:51], s35 offen sc1
    s_add_u32 s35, s34, 13824
    buffer_load_dwordx4 v[164:167], v4, s[48:51], s35 offen sc1
    s_add_u32 s35, s34, 15360
    buffer_load_dwordx4 v[168:171], v4, s[48:51], s35 offen sc1
    s_add_u32 s35, s34, 16896
    buffer_load_dwordx4 v[172:175], v4, s[48:51], s35 offen sc1
    s_add_u32 s35, s34, 18432
    buffer_load_dwordx4 v[176:179], v4, s[48:51], s35 offen sc1
    s_add_u32 s35, s34, 19968
    buffer_load_dwordx4 v[180:183], v4, s[48:51], s35 offen sc1
    s_add_u32 s35, s34, 21504
    buffer_load_dwordx4 v[184:187], v4, s[48:51], s35 offen sc1
    s_add_u32 s35, s34, 23040
    buffer_load_dwordx4 v[188:191], v4, s[48:51], s35 offen sc1
    s_waitcnt vmcnt(0)
    v_add_f32 v128, v128, v160
    v_add_f32 v129, v129, v161
    v_add_f32 v130, v130, v162
    v_add_f32 v131, v131, v163
    v_add_f32 v132, v132, v164
    v_add_f32 v133, v133, v165
    v_add_f32 v134, v134, v166
    v_add_f32 v135, v135, v167
    v_add_f32 v136, v136, v168
    v_add_f32 v137, v137, v169
    v_add_f32 v138, v138, v170
    v_add_f32 v139, v139, v171
    v_add_f32 v140, v140, v172
    v_add_f32 v141, v141, v173
    v_add_f32 v142, v142, v174
    v_add_f32 v143, v143, v175
    v_add_f32 v144, v144, v176
    v_add_f32 v145, v145, v177
    v_add_f32 v146, v146, v178
    v_add_f32 v147, v147, v179
    v_add_f32 v148, v148, v180
    v_add_f32 v149, v149, v181
    v_add_f32 v150, v150, v182
    v_add_f32 v151, v151, v183
    v_add_f32 v152, v152, v184
    v_add_f32 v153, v153, v185
    v_add_f32 v154, v154, v186
    v_add_f32 v155, v155, v187
    v_add_f32 v156, v156, v188
    v_add_f32 v157, v157, v189
    v_add_f32 v158, v158, v190
    v_add_f32 v159, v159, v191
    v_add_f32 v128, v128, v144
    v_add_f32 v129, v129, v145
    v_add_f32 v130, v130, v146
    v_add_f32 v131, v131, v147
    v_add_f32 v132, v132, v148
    v_add_f32 v133, v133, v149
    v_add_f32 v134, v134, v150
    v_add_f32 v135, v135, v151
    v_add_f32 v136, v136, v152
    v_add_f32 v137, v137, v153
    v_add_f32 v138, v138, v154
    v_add_f32 v139, v139, v155
    v_add_f32 v140, v140, v156
    v_add_f32 v141, v141, v157
    v_add_f32 v142, v142, v158
    v_add_f32 v143, v143, v159
    v_add_f32 v128, v128, v136
    v_add_f32 v129, v129, v137
    v_add_f32 v130, v130, v138
    v_add_f32 v131, v131, v139
    v_add_f32 v132, v132, v140
    v_add_f32 v133, v133, v141
    v_add_f32 v134, v134, v142
    v_add_f32 v135, v135, v143
    v_add_f32 v128, v128, v132
    v_add_f32 v129, v129, v133
    v_add_f32 v130, v130, v134
    v_add_f32 v131, v131, v135
    v_add_u32 v5, 64, v1
    v_mov_b32 v6, 1.0
    v_mov_b32 v132, 0xbfb8aa3b
    v_mov_b32 v133, 0xbf317218
    v_subrev_u32 v134, 24, v5
    v_cmp_gt_u32 vcc, 24, v134
    s_nop 1
    v_cndmask_b32 v6, v6, v132, vcc
    v_cmp_lt_u32 vcc, 71, v5
    s_nop 1
    v_cndmask_b32 v6, v6, v133, vcc
    v_mul_f32 v128, v128, v6
    v_mul_f32 v129, v129, v6
    v_mul_f32 v130, v130, v6
    v_mul_f32 v131, v131, v6
    v_add_u32 v5, 161024, v4
    ds_write_b128 v5, v[128:131]
    s_mov_b64 exec, -1
    s_waitcnt lgkmcnt(0)
    s_nop 1
SJ_28:
SE_22:
    s_barrier
    s_lshl_b32 s6, s69, 14
    s_add_u32 s6, s6, 7340032
    v_add_u32 v20, s6, v4
    v_add_u32 v21, 0x4000, v20
    s_lshl_b32 s7, s69, 7
    s_add_u32 s7, s7, 10485760
    v_lshlrev_b32 v22, 3, v2
    v_add_u32 v22, s7, v22
    buffer_load_dwordx4 a[0:3], v20, s[48:51], s12 offen sc1
    buffer_load_dwordx4 a[4:7], v21, s[48:51], s12 offen sc1
    buffer_load_dwordx4 a[8:11], v20, s[48:51], s13 offen sc1
    buffer_load_dwordx4 a[12:15], v21, s[48:51], s13 offen sc1
    buffer_load_dwordx4 a[16:19], v20, s[48:51], s14 offen sc1
    buffer_load_dwordx4 a[20:23], v21, s[48:51], s14 offen sc1
    buffer_load_dwordx4 a[24:27], v20, s[48:51], s15 offen sc1
    buffer_load_dwordx4 a[28:31], v21, s[48:51], s15 offen sc1
    buffer_load_dwordx4 a[32:35], v20, s[48:51], s16 offen sc1
    buffer_load_dwordx4 a[36:39], v21, s[48:51], s16 offen sc1
    buffer_load_dwordx4 a[40:43], v20, s[48:51], s17 offen sc1
    buffer_load_dwordx4 a[44:47], v21, s[48:51], s17 offen sc1
    v_add_u32 v16, 0x10000, v4
    v_add_u32 v17, 0x20000, v4
    v_lshlrev_b32 v18, 5, v3
    v_add_u32 v18, 160000, v18
    s_mul_i32 s6, s69, 44032
    s_lshl_b32 s7, s65, 10
    s_add_u32 s6, s6, s7
    s_add_u32 s6, s6, 11534336
    v_add_u32 v23, s6, v4
    v_add_u32 v24, 44032, v23
    s_add_u32 s6, s5, 1
    s_mul_i32 s6, s6, 0x5556
    s_lshr_b32 s6, s6, 13
    s_sub_u32 s6, s6, s65
    s_cmp_eq_u32 s5, 15
    s_cselect_b32 s6, 3, s6
    s_cmp_eq_u32 s6, 2
    s_cselect_b32 s32, 0x7f000000, 0
    s_mov_b32 s34, 0xbfb8aa3b
    s_waitcnt vmcnt(10)
    s_barrier
    ds_read_b128 v[128:131], v16 offset:32768
    ds_read_b128 v[132:135], v16 offset:33792
    ds_read_b128 v[136:139], v16 offset:34816
    ds_read_b128 v[140:143], v16 offset:35840
    ds_read_b128 v[144:147], v16 offset:36864
    ds_read_b128 v[148:151], v16 offset:37888
    ds_read_b128 v[152:155], v16 offset:38912
    ds_read_b128 v[156:159], v16 offset:39936
    s_waitcnt vmcnt(10) lgkmcnt(4)
    v_mfma_f32_16x16x32_bf16 v[64:67], v[128:131], a[0:3], 0
    ds_read_b128 v[160:163], v16 offset:40960
    v_mfma_f32_16x16x32_bf16 v[80:83], v[128:131], a[4:7], 0
    ds_read_b128 v[164:167], v16 offset:41984
    v_mfma_f32_16x16x32_bf16 v[68:71], v[132:135], a[0:3], 0
    ds_read_b128 v[168:171], v16 offset:43008
    v_mfma_f32_16x16x32_bf16 v[84:87], v[132:135], a[4:7], 0
    ds_read_b128 v[172:175], v16 offset:44032
    v_mfma_f32_16x16x32_bf16 v[72:75], v[136:139], a[0:3], 0
    buffer_load_dwordx4 a[48:51], v20, s[48:51], s18 offen sc1
    buffer_load_dwordx4 a[52:55], v21, s[48:51], s18 offen sc1
    v_mfma_f32_16x16x32_bf16 v[88:91], v[136:139], a[4:7], 0
    v_mfma_f32_16x16x32_bf16 v[76:79], v[140:143], a[0:3], 0
    s_mov_b32 s35, 0
    buffer_load_dwordx2 v[192:193], v22, s[48:51], s35 offen offset:0 sc1
    buffer_load_dwordx2 v[208:209], v22, s[48:51], s35 offen offset:128 sc1
    v_mfma_f32_16x16x32_bf16 v[92:95], v[140:143], a[4:7], 0
    s_waitcnt vmcnt(12) lgkmcnt(4)
    v_mfma_f32_16x16x32_bf16 v[64:67], v[144:147], a[8:11], v[64:67]
    ds_read_b128 v[128:131], v16 offset:45056
    v_mfma_f32_16x16x32_bf16 v[80:83], v[144:147], a[12:15], v[80:83]
    ds_read_b128 v[132:135], v16 offset:46080
    v_mfma_f32_16x16x32_bf16 v[68:71], v[148:151], a[8:11], v[68:71]
    ds_read_b128 v[136:139], v16 offset:47104
    v_mfma_f32_16x16x32_bf16 v[84:87], v[148:151], a[12:15], v[84:87]
    ds_read_b128 v[140:143], v16 offset:48128
    v_mfma_f32_16x16x32_bf16 v[72:75], v[152:155], a[8:11], v[72:75]
    buffer_load_dwordx4 a[56:59], v20, s[48:51], s19 offen sc1
    buffer_load_dwordx4 a[60:63], v21, s[48:51], s19 offen sc1
    v_mfma_f32_16x16x32_bf16 v[88:91], v[152:155], a[12:15], v[88:91]
    v_mfma_f32_16x16x32_bf16 v[76:79], v[156:159], a[8:11], v[76:79]
    s_mov_b32 s35, 16384
    buffer_load_dwordx2 v[194:195], v22, s[48:51], s35 offen offset:0 sc1
    buffer_load_dwordx2 v[210:211], v22, s[48:51], s35 offen offset:128 sc1
    v_mfma_f32_16x16x32_bf16 v[92:95], v[156:159], a[12:15], v[92:95]
    s_waitcnt vmcnt(14) lgkmcnt(4)
    v_mfma_f32_16x16x32_bf16 v[64:67], v[160:163], a[16:19], v[64:67]
    ds_read_b128 v[144:147], v16 offset:49152
    v_mfma_f32_16x16x32_bf16 v[80:83], v[160:163], a[20:23], v[80:83]
    ds_read_b128 v[148:151], v16 offset:50176
    v_mfma_f32_16x16x32_bf16 v[68:71], v[164:167], a[16:19], v[68:71]
    ds_read_b128 v[152:155], v16 offset:51200
    v_mfma_f32_16x16x32_bf16 v[84:87], v[164:167], a[20:23], v[84:87]
    ds_read_b128 v[156:159], v16 offset:52224
    v_mfma_f32_16x16x32_bf16 v[72:75], v[168:171], a[16:19], v[72:75]
    buffer_load_dwordx4 a[64:67], v20, s[48:51], s20 offen sc1
    buffer_load_dwordx4 a[68:71], v21, s[48:51], s20 offen sc1
    v_mfma_f32_16x16x32_bf16 v[88:91], v[168:171], a[20:23], v[88:91]
    v_mfma_f32_16x16x32_bf16 v[76:79], v[172:175], a[16:19], v[76:79]
    s_mov_b32 s35, 32768
    buffer_load_dwordx2 v[196:197], v22, s[48:51], s35 offen offset:0 sc1
    buffer_load_dwordx2 v[212:213], v22, s[48:51], s35 offen offset:128 sc1
    v_mfma_f32_16x16x32_bf16 v[92:95], v[172:175], a[20:23], v[92:95]
    s_waitcnt vmcnt(16) lgkmcnt(4)
    v_mfma_f32_16x16x32_bf16 v[64:67], v[128:131], a[24:27], v[64:67]
    ds_read_b128 v[160:163], v16 offset:53248
    v_mfma_f32_16x16x32_bf16 v[80:83], v[128:131], a[28:31], v[80:83]
    ds_read_b128 v[164:167], v16 offset:54272
    v_mfma_f32_16x16x32_bf16 v[68:71], v[132:135], a[24:27], v[68:71]
    ds_read_b128 v[168:171], v16 offset:55296
    v_mfma_f32_16x16x32_bf16 v[84:87], v[132:135], a[28:31], v[84:87]
    ds_read_b128 v[172:175], v16 offset:56320
    v_mfma_f32_16x16x32_bf16 v[72:75], v[136:139], a[24:27], v[72:75]
    buffer_load_dwordx4 a[72:75], v20, s[48:51], s21 offen sc1
    buffer_load_dwordx4 a[76:79], v21, s[48:51], s21 offen sc1
    v_mfma_f32_16x16x32_bf16 v[88:91], v[136:139], a[28:31], v[88:91]
    v_mfma_f32_16x16x32_bf16 v[76:79], v[140:143], a[24:27], v[76:79]
    s_mov_b32 s35, 49152
    buffer_load_dwordx2 v[198:199], v22, s[48:51], s35 offen offset:0 sc1
    buffer_load_dwordx2 v[214:215], v22, s[48:51], s35 offen offset:128 sc1
    v_mfma_f32_16x16x32_bf16 v[92:95], v[140:143], a[28:31], v[92:95]
    s_waitcnt vmcnt(18) lgkmcnt(4)
    v_mfma_f32_16x16x32_bf16 v[64:67], v[144:147], a[32:35], v[64:67]
    ds_read_b128 v[128:131], v16 offset:57344
    v_mfma_f32_16x16x32_bf16 v[80:83], v[144:147], a[36:39], v[80:83]
    ds_read_b128 v[132:135], v16 offset:58368
    v_mfma_f32_16x16x32_bf16 v[68:71], v[148:151], a[32:35], v[68:71]
    ds_read_b128 v[136:139], v16 offset:59392
    v_mfma_f32_16x16x32_bf16 v[84:87], v[148:151], a[36:39], v[84:87]
    ds_read_b128 v[140:143], v16 offset:60416
    v_mfma_f32_16x16x32_bf16 v[72:75], v[152:155], a[32:35], v[72:75]
    buffer_load_dwordx4 a[80:83], v20, s[48:51], s22 offen sc1
    buffer_load_dwordx4 a[84:87], v21, s[48:51], s22 offen sc1
    v_mfma_f32_16x16x32_bf16 v[88:91], v[152:155], a[36:39], v[88:91]
    v_mfma_f32_16x16x32_bf16 v[76:79], v[156:159], a[32:35], v[76:79]
    s_mov_b32 s35, 65536
    buffer_load_dwordx2 v[200:201], v22, s[48:51], s35 offen offset:0 sc1
    buffer_load_dwordx2 v[216:217], v22, s[48:51], s35 offen offset:128 sc1
    v_mfma_f32_16x16x32_bf16 v[92:95], v[156:159], a[36:39], v[92:95]
    s_waitcnt vmcnt(20) lgkmcnt(4)
    v_mfma_f32_16x16x32_bf16 v[64:67], v[160:163], a[40:43], v[64:67]
    ds_read_b128 v[144:147], v16 offset:61440
    v_mfma_f32_16x16x32_bf16 v[80:83], v[160:163], a[44:47], v[80:83]
    ds_read_b128 v[148:151], v16 offset:62464
    v_mfma_f32_16x16x32_bf16 v[68:71], v[164:167], a[40:43], v[68:71]
    ds_read_b128 v[152:155], v16 offset:63488
    v_mfma_f32_16x16x32_bf16 v[84:87], v[164:167], a[44:47], v[84:87]
    ds_read_b128 v[156:159], v16 offset:64512
    v_mfma_f32_16x16x32_bf16 v[72:75], v[168:171], a[40:43], v[72:75]
    buffer_load_dwordx4 a[88:91], v20, s[48:51], s23 offen sc1
    buffer_load_dwordx4 a[92:95], v21, s[48:51], s23 offen sc1
    v_mfma_f32_16x16x32_bf16 v[88:91], v[168:171], a[44:47], v[88:91]
    v_mfma_f32_16x16x32_bf16 v[76:79], v[172:175], a[40:43], v[76:79]
    s_mov_b32 s35, 81920
    buffer_load_dwordx2 v[202:203], v22, s[48:51], s35 offen offset:0 sc1
    buffer_load_dwordx2 v[218:219], v22, s[48:51], s35 offen offset:128 sc1
    v_mfma_f32_16x16x32_bf16 v[92:95], v[172:175], a[44:47], v[92:95]
    s_waitcnt vmcnt(22) lgkmcnt(4)
    v_mfma_f32_16x16x32_bf16 v[64:67], v[128:131], a[48:51], v[64:67]
    ds_read_b128 v[160:163], v17 offset:0
    v_mfma_f32_16x16x32_bf16 v[80:83], v[128:131], a[52:55], v[80:83]
    ds_read_b128 v[164:167], v17 offset:1024
    v_mfma_f32_16x16x32_bf16 v[68:71], v[132:135], a[48:51], v[68:71]
    ds_read_b128 v[168:171], v17 offset:2048
    v_mfma_f32_16x16x32_bf16 v[84:87], v[132:135], a[52:55], v[84:87]
    ds_read_b128 v[172:175], v17 offset:3072
    v_mfma_f32_16x16x32_bf16 v[72:75], v[136:139], a[48:51], v[72:75]
    buffer_load_dwordx4 a[96:99], v20, s[48:51], s24 offen sc1
    buffer_load_dwordx4 a[100:103], v21, s[48:51], s24 offen sc1
    v_mfma_f32_16x16x32_bf16 v[88:91], v[136:139], a[52:55], v[88:91]
    v_mfma_f32_16x16x32_bf16 v[76:79], v[140:143], a[48:51], v[76:79]
    s_mov_b32 s35, 98304
    buffer_load_dwordx2 v[204:205], v22, s[48:51], s35 offen offset:0 sc1
    buffer_load_dwordx2 v[220:221], v22, s[48:51], s35 offen offset:128 sc1
    v_mfma_f32_16x16x32_bf16 v[92:95], v[140:143], a[52:55], v[92:95]
    s_waitcnt vmcnt(22) lgkmcnt(4)
    v_mfma_f32_16x16x32_bf16 v[64:67], v[144:147], a[56:59], v[64:67]
    ds_read_b128 v[128:131], v17 offset:4096
    v_mfma_f32_16x16x32_bf16 v[80:83], v[144:147], a[60:63], v[80:83]
    ds_read_b128 v[132:135], v17 offset:5120
    v_mfma_f32_16x16x32_bf16 v[68:71], v[148:151], a[56:59], v[68:71]
    ds_read_b128 v[136:139], v17 offset:6144
    v_mfma_f32_16x16x32_bf16 v[84:87], v[148:151], a[60:63], v[84:87]
    ds_read_b128 v[140:143], v17 offset:7168
    v_mfma_f32_16x16x32_bf16 v[72:75], v[152:155], a[56:59], v[72:75]
    buffer_load_dwordx4 a[104:107], v20, s[48:51], s25 offen sc1
    buffer_load_dwordx4 a[108:111], v21, s[48:51], s25 offen sc1
    v_mfma_f32_16x16x32_bf16 v[88:91], v[152:155], a[60:63], v[88:91]
    v_mfma_f32_16x16x32_bf16 v[76:79], v[156:159], a[56:59], v[76:79]
    s_mov_b32 s35, 114688
    buffer_load_dwordx2 v[206:207], v22, s[48:51], s35 offen offset:0 sc1
    buffer_load_dwordx2 v[222:223], v22, s[48:51], s35 offen offset:128 sc1
    v_mfma_f32_16x16x32_bf16 v[92:95], v[156:159], a[60:63], v[92:95]
    s_waitcnt vmcnt(22) lgkmcnt(4)
    v_mfma_f32_16x16x32_bf16 v[64:67], v[160:163], a[64:67], v[64:67]
    ds_read_b128 v[144:147], v17 offset:8192
    v_mfma_f32_16x16x32_bf16 v[80:83], v[160:163], a[68:71], v[80:83]
    ds_read_b128 v[148:151], v17 offset:9216
    v_mfma_f32_16x16x32_bf16 v[68:71], v[164:167], a[64:67], v[68:71]
    ds_read_b128 v[152:155], v17 offset:10240
    v_mfma_f32_16x16x32_bf16 v[84:87], v[164:167], a[68:71], v[84:87]
    ds_read_b128 v[156:159], v17 offset:11264
    v_mfma_f32_16x16x32_bf16 v[72:75], v[168:171], a[64:67], v[72:75]
    buffer_load_dwordx4 a[112:115], v20, s[48:51], s26 offen sc1
    buffer_load_dwordx4 a[116:119], v21, s[48:51], s26 offen sc1
    v_mfma_f32_16x16x32_bf16 v[88:91], v[168:171], a[68:71], v[88:91]
    v_mfma_f32_16x16x32_bf16 v[76:79], v[172:175], a[64:67], v[76:79]
    v_mfma_f32_16x16x32_bf16 v[92:95], v[172:175], a[68:71], v[92:95]
    s_waitcnt vmcnt(20) lgkmcnt(4)
    v_mfma_f32_16x16x32_bf16 v[64:67], v[128:131], a[72:75], v[64:67]
    ds_read_b128 v[160:163], v17 offset:12288
    v_mfma_f32_16x16x32_bf16 v[80:83], v[128:131], a[76:79], v[80:83]
    ds_read_b128 v[164:167], v17 offset:13312
    v_mfma_f32_16x16x32_bf16 v[68:71], v[132:135], a[72:75], v[68:71]
    ds_read_b128 v[168:171], v17 offset:14336
    v_mfma_f32_16x16x32_bf16 v[84:87], v[132:135], a[76:79], v[84:87]
    ds_read_b128 v[172:175], v17 offset:15360
    v_mfma_f32_16x16x32_bf16 v[72:75], v[136:139], a[72:75], v[72:75]
    buffer_load_dwordx4 a[120:123], v20, s[48:51], s27 offen sc1
    buffer_load_dwordx4 a[124:127], v21, s[48:51], s27 offen sc1
    v_mfma_f32_16x16x32_bf16 v[88:91], v[136:139], a[76:79], v[88:91]
    v_mfma_f32_16x16x32_bf16 v[76:79], v[140:143], a[72:75], v[76:79]
    v_mfma_f32_16x16x32_bf16 v[92:95], v[140:143], a[76:79], v[92:95]
    s_waitcnt vmcnt(18) lgkmcnt(4)
    v_mfma_f32_16x16x32_bf16 v[64:67], v[144:147], a[80:83], v[64:67]
    ds_read_b128 v[128:131], v4 offset:49152
    v_mfma_f32_16x16x32_bf16 v[80:83], v[144:147], a[84:87], v[80:83]
    ds_read_b128 v[132:135], v4 offset:50176
    v_mfma_f32_16x16x32_bf16 v[68:71], v[148:151], a[80:83], v[68:71]
    ds_read_b128 v[136:139], v4 offset:51200
    v_mfma_f32_16x16x32_bf16 v[84:87], v[148:151], a[84:87], v[84:87]
    ds_read_b128 v[140:143], v4 offset:52224
    v_mfma_f32_16x16x32_bf16 v[72:75], v[152:155], a[80:83], v[72:75]
    s_add_u32 m0, s76, 0
    s_nop 0
    buffer_load_dwordx4 v13, s[48:51], s20 offen sc1 lds
    v_mfma_f32_16x16x32_bf16 v[88:91], v[152:155], a[84:87], v[88:91]
    v_mfma_f32_16x16x32_bf16 v[76:79], v[156:159], a[80:83], v[76:79]
    s_add_u32 m0, s76, 4096
    s_nop 0
    buffer_load_dwordx4 v13, s[48:51], s21 offen sc1 lds
    v_mfma_f32_16x16x32_bf16 v[92:95], v[156:159], a[84:87], v[92:95]
    s_waitcnt vmcnt(6)
    s_waitcnt vmcnt(16) lgkmcnt(4)
    v_mfma_f32_16x16x32_bf16 v[64:67], v[160:163], a[88:91], v[64:67]
    ds_read_b128 v[144:147], v4 offset:53248
    v_add_f32 v26, v192, v194
    v_add_f32 v27, v193, v195
    v_mfma_f32_16x16x32_bf16 v[80:83], v[160:163], a[92:95], v[80:83]
    ds_read_b128 v[148:151], v4 offset:54272
    v_add_f32 v26, v26, v196
    v_add_f32 v27, v27, v197
    v_mfma_f32_16x16x32_bf16 v[68:71], v[164:167], a[88:91], v[68:71]
    ds_read_b128 v[152:155], v4 offset:55296
    v_add_f32 v26, v26, v198
    v_add_f32 v27, v27, v199
    v_mfma_f32_16x16x32_bf16 v[84:87], v[164:167], a[92:95], v[84:87]
    ds_read_b128 v[156:159], v4 offset:56320
    v_add_f32 v26, v26, v200
    v_add_f32 v27, v27, v201
    v_mfma_f32_16x16x32_bf16 v[72:75], v[168:171], a[88:91], v[72:75]
    s_add_u32 m0, s76, 8192
    s_nop 0
    buffer_load_dwordx4 v13, s[48:51], s22 offen sc1 lds
    v_mfma_f32_16x16x32_bf16 v[88:91], v[168:171], a[92:95], v[88:91]
    v_add_f32 v26, v26, v202
    v_add_f32 v27, v27, v203
    v_add_f32 v26, v26, v204
    v_mfma_f32_16x16x32_bf16 v[76:79], v[172:175], a[88:91], v[76:79]
    s_add_u32 m0, s76, 12288
    s_nop 0
    buffer_load_dwordx4 v13, s[48:51], s23 offen sc1 lds
    v_mfma_f32_16x16x32_bf16 v[92:95], v[172:175], a[92:95], v[92:95]
    v_add_f32 v27, v27, v205
    v_add_f32 v26, v26, v206
    v_add_f32 v27, v27, v207
    s_waitcnt vmcnt(14) lgkmcnt(4)
    v_mfma_f32_16x16x32_bf16 v[64:67], v[128:131], a[96:99], v[64:67]
    ds_read_b128 v[160:163], v4 offset:57344
    v_mul_f32 v26, 0x3e000000, v26
    v_mov_b32 v31, 0
    v_mfma_f32_16x16x32_bf16 v[80:83], v[128:131], a[100:103], v[80:83]
    ds_read_b128 v[164:167], v4 offset:58368
    v_sub_f32 v30, v192, v26
    v_fmac_f32 v31, v30, v30
    v_mfma_f32_16x16x32_bf16 v[68:71], v[132:135], a[96:99], v[68:71]
    ds_read_b128 v[168:171], v4 offset:59392
    v_sub_f32 v30, v194, v26
    v_fmac_f32 v31, v30, v30
    v_mfma_f32_16x16x32_bf16 v[84:87], v[132:135], a[100:103], v[84:87]
    ds_read_b128 v[172:175], v4 offset:60416
    v_sub_f32 v30, v196, v26
    v_fmac_f32 v31, v30, v30
    v_mfma_f32_16x16x32_bf16 v[72:75], v[136:139], a[96:99], v[72:75]
    s_add_u32 m0, s76, 16384
    s_nop 0
    buffer_load_dwordx4 v13, s[48:51], s24 offen sc1 lds
    v_mfma_f32_16x16x32_bf16 v[88:91], v[136:139], a[100:103], v[88:91]
    v_sub_f32 v30, v198, v26
    v_fmac_f32 v31, v30, v30
    v_sub_f32 v30, v200, v26
    v_mfma_f32_16x16x32_bf16 v[76:79], v[140:143], a[96:99], v[76:79]
    s_add_u32 m0, s76, 20480
    s_nop 0
    buffer_load_dwordx4 v13, s[48:51], s25 offen sc1 lds
    v_mfma_f32_16x16x32_bf16 v[92:95], v[140:143], a[100:103], v[92:95]
    v_fmac_f32 v31, v30, v30
    v_sub_f32 v30, v202, v26
    v_fmac_f32 v31, v30, v30
    s_waitcnt vmcnt(12) lgkmcnt(4)
    v_mfma_f32_16x16x32_bf16 v[64:67], v[144:147], a[104:107], v[64:67]
    ds_read_b128 v[128:131], v4 offset:61440
    v_sub_f32 v30, v204, v26
    v_fmac_f32 v31, v30, v30
    v_mfma_f32_16x16x32_bf16 v[80:83], v[144:147], a[108:111], v[80:83]
    ds_read_b128 v[132:135], v4 offset:62464
    v_sub_f32 v30, v206, v26
    v_fmac_f32 v31, v30, v30
    v_mfma_f32_16x16x32_bf16 v[68:71], v[148:151], a[104:107], v[68:71]
    ds_read_b128 v[136:139], v4 offset:63488
    v_mov_b32 v30, 0x42800000
    v_fmac_f32 v27, v31, v30
    v_mfma_f32_16x16x32_bf16 v[84:87], v[148:151], a[108:111], v[84:87]
    ds_read_b128 v[140:143], v4 offset:64512
    v_mul_f32 v27, 0x3b000000, v27
    v_cvt_pk_bf16_f32 v26, v26, v26
    v_mfma_f32_16x16x32_bf16 v[72:75], v[152:155], a[104:107], v[72:75]
    s_add_u32 m0, s76, 24576
    s_nop 0
    buffer_load_dwordx4 v13, s[48:51], s26 offen sc1 lds
    v_mfma_f32_16x16x32_bf16 v[88:91], v[152:155], a[108:111], v[88:91]
    v_and_b32 v26, 0xffff0000, v26
    v_cvt_pk_bf16_f32 v27, v27, v27
    v_and_b32 v27, 0xffff0000, v27
    v_mfma_f32_16x16x32_bf16 v[76:79], v[156:159], a[104:107], v[76:79]
    s_add_u32 m0, s76, 28672
    s_nop 0
    buffer_load_dwordx4 v13, s[48:51], s27 offen sc1 lds
    v_mfma_f32_16x16x32_bf16 v[92:95], v[156:159], a[108:111], v[92:95]
    v_add_f32 v27, 0x3727c5ac, v27
    v_cvt_pk_bf16_f32 v27, v27, v27
    v_and_b32 v27, 0xffff0000, v27
    s_waitcnt vmcnt(10) lgkmcnt(4)
    v_mfma_f32_16x16x32_bf16 v[64:67], v[160:163], a[112:115], v[64:67]
    ds_read_b128 v[144:147], v16 offset:0
    v_sqrt_f32 v27, v27
    s_nop 0
    v_cvt_pk_bf16_f32 v27, v27, v27
    v_mfma_f32_16x16x32_bf16 v[80:83], v[160:163], a[116:119], v[80:83]
    ds_read_b128 v[148:151], v16 offset:1024
    v_and_b32 v27, 0xffff0000, v27
    v_rcp_f32 v27, v27
    v_mfma_f32_16x16x32_bf16 v[68:71], v[164:167], a[112:115], v[68:71]
    ds_read_b128 v[152:155], v16 offset:2048
    v_mul_f32 v30, 0xbf317218, v27
    v_mul_f32 v27, 0xbfb8aa3b, v27
    v_mfma_f32_16x16x32_bf16 v[84:87], v[164:167], a[116:119], v[84:87]
    ds_read_b128 v[156:159], v16 offset:3072
    v_add_f32 v28, v208, v210
    v_add_f32 v29, v209, v211
    v_mfma_f32_16x16x32_bf16 v[72:75], v[168:171], a[112:115], v[72:75]
    s_add_u32 m0, s76, 32768
    s_nop 0
    buffer_load_dwordx4 v14, s[48:51], s12 offen sc1 lds
    v_mfma_f32_16x16x32_bf16 v[88:91], v[168:171], a[116:119], v[88:91]
    v_add_f32 v28, v28, v212
    v_add_f32 v29, v29, v213
    v_add_f32 v28, v28, v214
    v_mfma_f32_16x16x32_bf16 v[76:79], v[172:175], a[112:115], v[76:79]
    s_add_u32 m0, s76, 36864
    s_nop 0
    buffer_load_dwordx4 v14, s[48:51], s13 offen sc1 lds
    v_mfma_f32_16x16x32_bf16 v[92:95], v[172:175], a[116:119], v[92:95]
    v_add_f32 v29, v29, v215
    v_add_f32 v28, v28, v216
    v_add_f32 v29, v29, v217
    s_waitcnt vmcnt(10) lgkmcnt(4)
    v_mfma_f32_16x16x32_bf16 v[64:67], v[128:131], a[120:123], v[64:67]
    ds_read_b128 v[160:163], v16 offset:4096
    v_add_f32 v28, v28, v218
    v_add_f32 v29, v29, v219
    v_mfma_f32_16x16x32_bf16 v[80:83], v[128:131], a[124:127], v[80:83]
    ds_read_b128 v[164:167], v16 offset:5120
    v_add_f32 v28, v28, v220
    v_add_f32 v29, v29, v221
    v_mfma_f32_16x16x32_bf16 v[68:71], v[132:135], a[120:123], v[68:71]
    ds_read_b128 v[168:171], v16 offset:6144
    v_add_f32 v28, v28, v222
    v_add_f32 v29, v29, v223
    v_mfma_f32_16x16x32_bf16 v[84:87], v[132:135], a[124:127], v[84:87]
    ds_read_b128 v[172:175], v16 offset:7168
    v_mul_f32 v28, 0x3e000000, v28
    v_mov_b32 v33, 0
    v_mfma_f32_16x16x32_bf16 v[72:75], v[136:139], a[120:123], v[72:75]
    s_add_u32 m0, s76, 40960
    s_nop 0
    buffer_load_dwordx4 v14, s[48:51], s14 offen sc1 lds
    v_mfma_f32_16x16x32_bf16 v[88:91], v[136:139], a[124:127], v[88:91]
    v_sub_f32 v32, v208, v28
    v_fmac_f32 v33, v32, v32
    v_sub_f32 v32, v210, v28
    v_mfma_f32_16x16x32_bf16 v[76:79], v[140:143], a[120:123], v[76:79]
    s_add_u32 m0, s76, 45056
    s_nop 0
    buffer_load_dwordx4 v14, s[48:51], s15 offen sc1 lds
    v_mfma_f32_16x16x32_bf16 v[92:95], v[140:143], a[124:127], v[92:95]
    v_fmac_f32 v33, v32, v32
    v_sub_f32 v32, v212, v28
    v_fmac_f32 v33, v32, v32
    v_sub_f32 v32, v214, v28
    v_fmac_f32 v33, v32, v32
    v_sub_f32 v32, v216, v28
    v_fmac_f32 v33, v32, v32
    v_sub_f32 v32, v218, v28
    v_fmac_f32 v33, v32, v32
    v_sub_f32 v32, v220, v28
    v_fmac_f32 v33, v32, v32
    v_sub_f32 v32, v222, v28
    v_fmac_f32 v33, v32, v32
    v_mov_b32 v32, 0x42800000
    v_fmac_f32 v29, v33, v32
    v_mul_f32 v29, 0x3b000000, v29
    v_cvt_pk_bf16_f32 v28, v28, v28
    v_and_b32 v28, 0xffff0000, v28
    v_cvt_pk_bf16_f32 v29, v29, v29
    v_and_b32 v29, 0xffff0000, v29
    v_add_f32 v29, 0x3727c5ac, v29
    v_cvt_pk_bf16_f32 v29, v29, v29
    v_and_b32 v29, 0xffff0000, v29
    v_sqrt_f32 v29, v29
    s_nop 0
    v_cvt_pk_bf16_f32 v29, v29, v29
    v_and_b32 v29, 0xffff0000, v29
    v_rcp_f32 v29, v29
    s_nop 0
    v_mul_f32 v32, 0xbf317218, v29
    v_mul_f32 v29, 0xbfb8aa3b, v29
    ds_read_b128 v[176:179], v18 offset:0
    ds_read_b128 v[180:183], v18 offset:16
    ds_read_b128 v[184:187], v18 offset:384
    ds_read_b128 v[188:191], v18 offset:400
    ds_read_b128 v[192:195], v18 offset:768
    ds_read_b128 v[196:199], v18 offset:784
    ds_read_b128 v[200:203], v18 offset:1152
    ds_read_b128 v[204:207], v18 offset:1168
    s_waitcnt lgkmcnt(0)
    s_barrier
    s_waitcnt lgkmcnt(4)
    v_mfma_f32_16x16x32_bf16 v[96:99], v[144:147], a[0:3], 0
    ds_read_b128 v[128:131], v16 offset:8192
    v_fma_f32 v64, -v26, v176, v64
    v_fma_f32 v72, -v26, v192, v72
    v_mfma_f32_16x16x32_bf16 v[112:115], v[144:147], a[4:7], 0
    ds_read_b128 v[132:135], v16 offset:9216
    v_fma_f32 v65, -v26, v177, v65
    v_fma_f32 v73, -v26, v193, v73
    v_mfma_f32_16x16x32_bf16 v[100:103], v[148:151], a[0:3], 0
    ds_read_b128 v[136:139], v16 offset:10240
    v_fma_f32 v66, -v26, v178, v66
    v_fma_f32 v74, -v26, v194, v74
    v_mfma_f32_16x16x32_bf16 v[116:119], v[148:151], a[4:7], 0
    ds_read_b128 v[140:143], v16 offset:11264
    v_fma_f32 v67, -v26, v179, v67
    v_fma_f32 v75, -v26, v195, v75
    v_mfma_f32_16x16x32_bf16 v[104:107], v[152:155], a[0:3], 0
    s_add_u32 m0, s76, 98304
    s_nop 0
    buffer_load_dwordx4 v14, s[48:51], s16 offen sc1 lds
    v_mfma_f32_16x16x32_bf16 v[120:123], v[152:155], a[4:7], 0
    v_fma_f32 v68, -v26, v180, v68
    v_fma_f32 v76, -v26, v196, v76
    v_fma_f32 v69, -v26, v181, v69
    v_mfma_f32_16x16x32_bf16 v[108:111], v[156:159], a[0:3], 0
    s_add_u32 m0, s76, 102400
    s_nop 0
    buffer_load_dwordx4 v14, s[48:51], s17 offen sc1 lds
    v_mfma_f32_16x16x32_bf16 v[124:127], v[156:159], a[4:7], 0
    v_fma_f32 v77, -v26, v197, v77
    v_fma_f32 v70, -v26, v182, v70
    v_fma_f32 v78, -v26, v198, v78
    s_waitcnt lgkmcnt(4)
    v_mfma_f32_16x16x32_bf16 v[96:99], v[160:163], a[8:11], v[96:99]
    ds_read_b128 v[144:147], v16 offset:12288
    v_fma_f32 v71, -v26, v183, v71
    v_fma_f32 v79, -v26, v199, v79
    v_mfma_f32_16x16x32_bf16 v[112:115], v[160:163], a[12:15], v[112:115]
    ds_read_b128 v[148:151], v16 offset:13312
    v_fma_f32 v64, v64, v27, v184
    v_fma_f32 v72, v72, v30, v200
    v_mfma_f32_16x16x32_bf16 v[100:103], v[164:167], a[8:11], v[100:103]
    ds_read_b128 v[152:155], v16 offset:14336
    v_fma_f32 v65, v65, v27, v185
    v_fma_f32 v73, v73, v30, v201
    v_mfma_f32_16x16x32_bf16 v[116:119], v[164:167], a[12:15], v[116:119]
    ds_read_b128 v[156:159], v16 offset:15360
    v_fma_f32 v66, v66, v27, v186
    v_fma_f32 v74, v74, v30, v202
    v_mfma_f32_16x16x32_bf16 v[104:107], v[168:171], a[8:11], v[104:107]
    s_add_u32 m0, s76, 106496
    s_nop 0
    buffer_load_dwordx4 v14, s[48:51], s18 offen sc1 lds
    v_mfma_f32_16x16x32_bf16 v[120:123], v[168:171], a[12:15], v[120:123]
    v_fma_f32 v67, v67, v27, v187
    v_fma_f32 v75, v75, v30, v203
    v_fma_f32 v68, v68, v27, v188
    v_mfma_f32_16x16x32_bf16 v[108:111], v[172:175], a[8:11], v[108:111]
    s_add_u32 m0, s76, 110592
    s_nop 0
    buffer_load_dwordx4 v14, s[48:51], s19 offen sc1 lds
    v_mfma_f32_16x16x32_bf16 v[124:127], v[172:175], a[12:15], v[124:127]
    v_fma_f32 v76, v76, v30, v204
    v_fma_f32 v69, v69, v27, v189
    v_fma_f32 v77, v77, v30, v205
    s_waitcnt lgkmcnt(4)
    v_mfma_f32_16x16x32_bf16 v[96:99], v[128:131], a[16:19], v[96:99]
    ds_read_b128 v[160:163], v16 offset:16384
    v_fma_f32 v70, v70, v27, v190
    v_fma_f32 v78, v78, v30, v206
    v_mfma_f32_16x16x32_bf16 v[112:115], v[128:131], a[20:23], v[112:115]
    ds_read_b128 v[164:167], v16 offset:17408
    v_fma_f32 v71, v71, v27, v191
    v_fma_f32 v79, v79, v30, v207
    v_mfma_f32_16x16x32_bf16 v[100:103], v[132:135], a[16:19], v[100:103]
    ds_read_b128 v[168:171], v16 offset:18432
    v_exp_f32 v208, v64
    v_mul_f32 v64, v64, v72
    v_mfma_f32_16x16x32_bf16 v[116:119], v[132:135], a[20:23], v[116:119]
    ds_read_b128 v[172:175], v16 offset:19456
    v_exp_f32 v209, v65
    v_mul_f32 v65, v65, v73
    v_mfma_f32_16x16x32_bf16 v[104:107], v[136:139], a[16:19], v[104:107]
    s_add_u32 m0, s76, 114688
    s_nop 0
    buffer_load_dwordx4 v14, s[48:51], s20 offen sc1 lds
    v_mfma_f32_16x16x32_bf16 v[120:123], v[136:139], a[20:23], v[120:123]
    v_exp_f32 v210, v66
    v_mul_f32 v66, v66, v74
    v_exp_f32 v211, v67
    v_mfma_f32_16x16x32_bf16 v[108:111], v[140:143], a[16:19], v[108:111]
    s_add_u32 m0, s76, 118784
    s_nop 0
    buffer_load_dwordx4 v14, s[48:51], s21 offen sc1 lds
    v_mfma_f32_16x16x32_bf16 v[124:127], v[140:143], a[20:23], v[124:127]
    v_mul_f32 v67, v67, v75
    v_exp_f32 v212, v68
    v_mul_f32 v68, v68, v76
    s_waitcnt lgkmcnt(4)
    v_mfma_f32_16x16x32_bf16 v[96:99], v[144:147], a[24:27], v[96:99]
    ds_read_b128 v[128:131], v16 offset:20480
    v_exp_f32 v213, v69
    v_mul_f32 v69, v69, v77
    v_mfma_f32_16x16x32_bf16 v[112:115], v[144:147], a[28:31], v[112:115]
    ds_read_b128 v[132:135], v16 offset:21504
    v_exp_f32 v214, v70
    v_mul_f32 v70, v70, v78
    v_mfma_f32_16x16x32_bf16 v[100:103], v[148:151], a[24:27], v[100:103]
    ds_read_b128 v[136:139], v16 offset:22528
    v_exp_f32 v215, v71
    v_mul_f32 v71, v71, v79
    v_mfma_f32_16x16x32_bf16 v[116:119], v[148:151], a[28:31], v[116:119]
    ds_read_b128 v[140:143], v16 offset:23552
    v_add_f32 v208, 1.0, v208
    v_add_f32 v209, 1.0, v209
    v_mfma_f32_16x16x32_bf16 v[104:107], v[152:155], a[24:27], v[104:107]
    s_add_u32 m0, s76, 122880
    s_nop 0
    buffer_load_dwordx4 v14, s[48:51], s22 offen sc1 lds
    v_mfma_f32_16x16x32_bf16 v[120:123], v[152:155], a[28:31], v[120:123]
    v_add_f32 v210, 1.0, v210
    v_add_f32 v211, 1.0, v211
    v_add_f32 v212, 1.0, v212
    v_mfma_f32_16x16x32_bf16 v[108:111], v[156:159], a[24:27], v[108:111]
    s_add_u32 m0, s76, 126976
    s_nop 0
    buffer_load_dwordx4 v14, s[48:51], s23 offen sc1 lds
    v_mfma_f32_16x16x32_bf16 v[124:127], v[156:159], a[28:31], v[124:127]
    v_add_f32 v213, 1.0, v213
    v_add_f32 v214, 1.0, v214
    v_add_f32 v215, 1.0, v215
    s_waitcnt vmcnt(8)
    s_barrier
    s_waitcnt lgkmcnt(4)
    v_mfma_f32_16x16x32_bf16 v[96:99], v[160:163], a[32:35], v[96:99]
    ds_read_b128 v[144:147], v16 offset:24576
    v_rcp_f32 v208, v208
    v_rcp_f32 v209, v209
    v_mfma_f32_16x16x32_bf16 v[112:115], v[160:163], a[36:39], v[112:115]
    ds_read_b128 v[148:151], v16 offset:25600
    v_rcp_f32 v210, v210
    v_rcp_f32 v211, v211
    v_mfma_f32_16x16x32_bf16 v[100:103], v[164:167], a[32:35], v[100:103]
    ds_read_b128 v[152:155], v16 offset:26624
    v_rcp_f32 v212, v212
    v_rcp_f32 v213, v213
    v_mfma_f32_16x16x32_bf16 v[116:119], v[164:167], a[36:39], v[116:119]
    ds_read_b128 v[156:159], v16 offset:27648
    v_rcp_f32 v214, v214
    v_rcp_f32 v215, v215
    v_mfma_f32_16x16x32_bf16 v[104:107], v[168:171], a[32:35], v[104:107]
    s_add_u32 m0, s76, 131072
    s_nop 0
    buffer_load_dwordx4 v14, s[48:51], s24 offen sc1 lds
    v_mfma_f32_16x16x32_bf16 v[120:123], v[168:171], a[36:39], v[120:123]
    v_mul_f32 v208, v208, v64
    v_mul_f32 v209, v209, v65
    v_mul_f32 v210, v210, v66
    v_mfma_f32_16x16x32_bf16 v[108:111], v[172:175], a[32:35], v[108:111]
    s_add_u32 m0, s76, 135168
    s_nop 0
    buffer_load_dwordx4 v14, s[48:51], s25 offen sc1 lds
    v_mfma_f32_16x16x32_bf16 v[124:127], v[172:175], a[36:39], v[124:127]
    v_mul_f32 v211, v211, v67
    v_mul_f32 v212, v212, v68
    v_mul_f32 v213, v213, v69
    s_waitcnt lgkmcnt(4)
    v_mfma_f32_16x16x32_bf16 v[96:99], v[128:131], a[40:43], v[96:99]
    ds_read_b128 v[160:163], v16 offset:28672
    v_mul_f32 v214, v214, v70
    v_mul_f32 v215, v215, v71
    v_mfma_f32_16x16x32_bf16 v[112:115], v[128:131], a[44:47], v[112:115]
    ds_read_b128 v[164:167], v16 offset:29696
    v_cvt_pk_bf16_f32 v224, v208, v209
    v_cvt_pk_bf16_f32 v225, v210, v211
    v_mfma_f32_16x16x32_bf16 v[100:103], v[132:135], a[40:43], v[100:103]
    ds_read_b128 v[168:171], v16 offset:30720
    v_cvt_pk_bf16_f32 v226, v212, v213
    v_cvt_pk_bf16_f32 v227, v214, v215
    v_mfma_f32_16x16x32_bf16 v[116:119], v[132:135], a[44:47], v[116:119]
    ds_read_b128 v[172:175], v16 offset:31744
    buffer_store_dwordx4 v[224:227], v23, s[48:51], 0 offen offset:0 sc1
    v_fma_f32 v80, -v28, v176, v80
    v_mfma_f32_16x16x32_bf16 v[104:107], v[136:139], a[40:43], v[104:107]
    s_add_u32 m0, s76, 139264
    s_nop 0
    buffer_load_dwordx4 v14, s[48:51], s26 offen sc1 lds
    v_mfma_f32_16x16x32_bf16 v[120:123], v[136:139], a[44:47], v[120:123]
    v_fma_f32 v88, -v28, v192, v88
    v_fma_f32 v81, -v28, v177, v81
    v_fma_f32 v89, -v28, v193, v89
    v_mfma_f32_16x16x32_bf16 v[108:111], v[140:143], a[40:43], v[108:111]
    s_add_u32 m0, s76, 143360
    s_nop 0
    buffer_load_dwordx4 v14, s[48:51], s27 offen sc1 lds
    v_mfma_f32_16x16x32_bf16 v[124:127], v[140:143], a[44:47], v[124:127]
    v_fma_f32 v82, -v28, v178, v82
    v_fma_f32 v90, -v28, v194, v90
    v_fma_f32 v83, -v28, v179, v83
    s_waitcnt lgkmcnt(4)
    v_mfma_f32_16x16x32_bf16 v[96:99], v[144:147], a[48:51], v[96:99]
    ds_read_b128 v[128:131], v4 offset:0
    v_fma_f32 v91, -v28, v195, v91
    v_fma_f32 v84, -v28, v180, v84
    v_mfma_f32_16x16x32_bf16 v[112:115], v[144:147], a[52:55], v[112:115]
    ds_read_b128 v[132:135], v4 offset:1024
    v_fma_f32 v92, -v28, v196, v92
    v_fma_f32 v85, -v28, v181, v85
    v_mfma_f32_16x16x32_bf16 v[100:103], v[148:151], a[48:51], v[100:103]
    ds_read_b128 v[136:139], v4 offset:2048
    v_fma_f32 v93, -v28, v197, v93
    v_fma_f32 v86, -v28, v182, v86
    v_mfma_f32_16x16x32_bf16 v[116:119], v[148:151], a[52:55], v[116:119]
    ds_read_b128 v[140:143], v4 offset:3072
    v_fma_f32 v94, -v28, v198, v94
    v_fma_f32 v87, -v28, v183, v87
    v_mfma_f32_16x16x32_bf16 v[104:107], v[152:155], a[48:51], v[104:107]
    s_cmp_ge_u32 s52, 44032
    s_cselect_b32 s63, 0x7f000000, s52
    buffer_load_dwordx4 a[128:131], v9, s[48:51], s63 offen sc1
    v_mfma_f32_16x16x32_bf16 v[120:123], v[152:155], a[52:55], v[120:123]
    v_fma_f32 v95, -v28, v199, v95
    v_fma_f32 v80, v80, v29, v184
    v_fma_f32 v88, v88, v32, v200
    v_mfma_f32_16x16x32_bf16 v[108:111], v[156:159], a[48:51], v[108:111]
    s_add_u32 s79, s63, 44032
    buffer_load_dwordx4 a[132:135], v9, s[48:51], s79 offen sc1
    v_mfma_f32_16x16x32_bf16 v[124:127], v[156:159], a[52:55], v[124:127]
    v_fma_f32 v81, v81, v29, v185
    v_fma_f32 v89, v89, v32, v201
    v_fma_f32 v82, v82, v29, v186
    s_waitcnt lgkmcnt(4)
    v_mfma_f32_16x16x32_bf16 v[96:99], v[160:163], a[56:59], v[96:99]
    ds_read_b128 v[144:147], v4 offset:4096
    v_fma_f32 v90, v90, v32, v202
    v_fma_f32 v83, v83, v29, v187
    v_mfma_f32_16x16x32_bf16 v[112:115], v[160:163], a[60:63], v[112:115]
    ds_read_b128 v[148:151], v4 offset:5120
    v_fma_f32 v91, v91, v32, v203
    v_fma_f32 v84, v84, v29, v188
    v_mfma_f32_16x16x32_bf16 v[100:103], v[164:167], a[56:59], v[100:103]
    ds_read_b128 v[152:155], v4 offset:6144
    v_fma_f32 v92, v92, v32, v204
    v_fma_f32 v85, v85, v29, v189
    v_mfma_f32_16x16x32_bf16 v[116:119], v[164:167], a[60:63], v[116:119]
    ds_read_b128 v[156:159], v4 offset:7168
    v_fma_f32 v93, v93, v32, v205
    v_fma_f32 v86, v86, v29, v190
    v_mfma_f32_16x16x32_bf16 v[104:107], v[168:171], a[56:59], v[104:107]
    s_add_u32 s79, s63, 88064
    buffer_load_dwordx4 a[136:139], v9, s[48:51], s79 offen sc1
    v_mfma_f32_16x16x32_bf16 v[120:123], v[168:171], a[60:63], v[120:123]
    v_fma_f32 v94, v94, v32, v206
    v_fma_f32 v87, v87, v29, v191
    v_fma_f32 v95, v95, v32, v207
    v_mfma_f32_16x16x32_bf16 v[108:111], v[172:175], a[56:59], v[108:111]
    s_add_u32 s79, s63, 132096
    buffer_load_dwordx4 a[140:143], v9, s[48:51], s79 offen sc1
    v_mfma_f32_16x16x32_bf16 v[124:127], v[172:175], a[60:63], v[124:127]
    v_exp_f32 v216, v80
    v_mul_f32 v80, v80, v88
    v_exp_f32 v217, v81
    s_waitcnt lgkmcnt(4)
    v_mfma_f32_16x16x32_bf16 v[96:99], v[128:131], a[64:67], v[96:99]
    ds_read_b128 v[160:163], v4 offset:8192
    v_mul_f32 v81, v81, v89
    v_exp_f32 v218, v82
    v_mfma_f32_16x16x32_bf16 v[112:115], v[128:131], a[68:71], v[112:115]
    ds_read_b128 v[164:167], v4 offset:9216
    v_mul_f32 v82, v82, v90
    v_exp_f32 v219, v83
    v_mfma_f32_16x16x32_bf16 v[100:103], v[132:135], a[64:67], v[100:103]
    ds_read_b128 v[168:171], v4 offset:10240
    v_mul_f32 v83, v83, v91
    v_exp_f32 v220, v84
    v_mfma_f32_16x16x32_bf16 v[116:119], v[132:135], a[68:71], v[116:119]
    ds_read_b128 v[172:175], v4 offset:11264
    v_mul_f32 v84, v84, v92
    v_exp_f32 v221, v85
    v_mfma_f32_16x16x32_bf16 v[104:107], v[136:139], a[64:67], v[104:107]
    s_cmp_ge_u32 s53, 44032
    s_cselect_b32 s63, 0x7f000000, s53
    buffer_load_dwordx4 a[144:147], v9, s[48:51], s63 offen sc1
    v_mfma_f32_16x16x32_bf16 v[120:123], v[136:139], a[68:71], v[120:123]
    v_mul_f32 v85, v85, v93
    v_exp_f32 v222, v86
    v_mul_f32 v86, v86, v94
    v_mfma_f32_16x16x32_bf16 v[108:111], v[140:143], a[64:67], v[108:111]
    s_add_u32 s79, s63, 44032
    buffer_load_dwordx4 a[148:151], v9, s[48:51], s79 offen sc1
    v_mfma_f32_16x16x32_bf16 v[124:127], v[140:143], a[68:71], v[124:127]
    v_exp_f32 v223, v87
    v_mul_f32 v87, v87, v95
    v_add_f32 v216, 1.0, v216
    s_waitcnt lgkmcnt(4)
    v_mfma_f32_16x16x32_bf16 v[96:99], v[144:147], a[72:75], v[96:99]
    ds_read_b128 v[128:131], v4 offset:12288
    v_add_f32 v217, 1.0, v217
    v_add_f32 v218, 1.0, v218
    v_mfma_f32_16x16x32_bf16 v[112:115], v[144:147], a[76:79], v[112:115]
    ds_read_b128 v[132:135], v4 offset:13312
    v_add_f32 v219, 1.0, v219
    v_add_f32 v220, 1.0, v220
    v_mfma_f32_16x16x32_bf16 v[100:103], v[148:151], a[72:75], v[100:103]
    ds_read_b128 v[136:139], v4 offset:14336
    v_add_f32 v221, 1.0, v221
    v_add_f32 v222, 1.0, v222
    v_mfma_f32_16x16x32_bf16 v[116:119], v[148:151], a[76:79], v[116:119]
    ds_read_b128 v[140:143], v4 offset:15360
    v_add_f32 v223, 1.0, v223
    v_rcp_f32 v216, v216
    v_mfma_f32_16x16x32_bf16 v[104:107], v[152:155], a[72:75], v[104:107]
    s_add_u32 s79, s63, 88064
    buffer_load_dwordx4 a[152:155], v9, s[48:51], s79 offen sc1
    v_mfma_f32_16x16x32_bf16 v[120:123], v[152:155], a[76:79], v[120:123]
    v_rcp_f32 v217, v217
    v_rcp_f32 v218, v218
    v_rcp_f32 v219, v219
    v_mfma_f32_16x16x32_bf16 v[108:111], v[156:159], a[72:75], v[108:111]
    s_add_u32 s79, s63, 132096
    buffer_load_dwordx4 a[156:159], v9, s[48:51], s79 offen sc1
    v_mfma_f32_16x16x32_bf16 v[124:127], v[156:159], a[76:79], v[124:127]
    v_rcp_f32 v220, v220
    v_rcp_f32 v221, v221
    v_rcp_f32 v222, v222
    s_waitcnt lgkmcnt(4)
    v_mfma_f32_16x16x32_bf16 v[96:99], v[160:163], a[80:83], v[96:99]
    ds_read_b128 v[144:147], v4 offset:16384
    v_rcp_f32 v223, v223
    v_mul_f32 v216, v216, v80
    v_mfma_f32_16x16x32_bf16 v[112:115], v[160:163], a[84:87], v[112:115]
    ds_read_b128 v[148:151], v4 offset:17408
    v_mul_f32 v217, v217, v81
    v_mul_f32 v218, v218, v82
    v_mfma_f32_16x16x32_bf16 v[100:103], v[164:167], a[80:83], v[100:103]
    ds_read_b128 v[152:155], v4 offset:18432
    v_mul_f32 v219, v219, v83
    v_mul_f32 v220, v220, v84
    v_mfma_f32_16x16x32_bf16 v[116:119], v[164:167], a[84:87], v[116:119]
    ds_read_b128 v[156:159], v4 offset:19456
    v_mul_f32 v221, v221, v85
    v_mul_f32 v222, v222, v86
    v_mfma_f32_16x16x32_bf16 v[104:107], v[168:171], a[80:83], v[104:107]
    s_cmp_ge_u32 s54, 44032
    s_cselect_b32 s63, 0x7f000000, s54
    buffer_load_dwordx4 a[160:163], v9, s[48:51], s63 offen sc1
    v_mfma_f32_16x16x32_bf16 v[120:123], v[168:171], a[84:87], v[120:123]
    v_mul_f32 v223, v223, v87
    v_cvt_pk_bf16_f32 v228, v216, v217
    v_cvt_pk_bf16_f32 v229, v218, v219
    v_mfma_f32_16x16x32_bf16 v[108:111], v[172:175], a[80:83], v[108:111]
    s_add_u32 s79, s63, 44032
    buffer_load_dwordx4 a[164:167], v9, s[48:51], s79 offen sc1
    v_mfma_f32_16x16x32_bf16 v[124:127], v[172:175], a[84:87], v[124:127]
    v_cvt_pk_bf16_f32 v230, v220, v221
    v_cvt_pk_bf16_f32 v231, v222, v223
    buffer_store_dwordx4 v[228:231], v24, s[48:51], 0 offen offset:0 sc1
    s_waitcnt lgkmcnt(4)
    v_mfma_f32_16x16x32_bf16 v[96:99], v[128:131], a[88:91], v[96:99]
    ds_read_b128 v[160:163], v4 offset:20480
    v_mfma_f32_16x16x32_bf16 v[112:115], v[128:131], a[92:95], v[112:115]
    ds_read_b128 v[164:167], v4 offset:21504
    v_mfma_f32_16x16x32_bf16 v[100:103], v[132:135], a[88:91], v[100:103]
    ds_read_b128 v[168:171], v4 offset:22528
    v_mfma_f32_16x16x32_bf16 v[116:119], v[132:135], a[92:95], v[116:119]
    ds_read_b128 v[172:175], v4 offset:23552
    v_mfma_f32_16x16x32_bf16 v[104:107], v[136:139], a[88:91], v[104:107]
    s_add_u32 s79, s63, 88064
    buffer_load_dwordx4 a[168:171], v9, s[48:51], s79 offen sc1
    v_mfma_f32_16x16x32_bf16 v[120:123], v[136:139], a[92:95], v[120:123]
    v_mfma_f32_16x16x32_bf16 v[108:111], v[140:143], a[88:91], v[108:111]
    s_add_u32 s79, s63, 132096
    buffer_load_dwordx4 a[172:175], v9, s[48:51], s79 offen sc1
    v_mfma_f32_16x16x32_bf16 v[124:127], v[140:143], a[92:95], v[124:127]
    s_waitcnt lgkmcnt(4)
    v_mfma_f32_16x16x32_bf16 v[96:99], v[144:147], a[96:99], v[96:99]
    ds_read_b128 v[128:131], v4 offset:24576
    v_mfma_f32_16x16x32_bf16 v[112:115], v[144:147], a[100:103], v[112:115]
    ds_read_b128 v[132:135], v4 offset:25600
    v_mfma_f32_16x16x32_bf16 v[100:103], v[148:151], a[96:99], v[100:103]
    ds_read_b128 v[136:139], v4 offset:26624
    v_mfma_f32_16x16x32_bf16 v[116:119], v[148:151], a[100:103], v[116:119]
    ds_read_b128 v[140:143], v4 offset:27648
    v_mfma_f32_16x16x32_bf16 v[104:107], v[152:155], a[96:99], v[104:107]
    v_mfma_f32_16x16x32_bf16 v[120:123], v[152:155], a[100:103], v[120:123]
    v_mfma_f32_16x16x32_bf16 v[108:111], v[156:159], a[96:99], v[108:111]
    v_mfma_f32_16x16x32_bf16 v[124:127], v[156:159], a[100:103], v[124:127]
    s_waitcnt lgkmcnt(4)
    v_mfma_f32_16x16x32_bf16 v[96:99], v[160:163], a[104:107], v[96:99]
    ds_read_b128 v[144:147], v4 offset:28672
    v_mfma_f32_16x16x32_bf16 v[112:115], v[160:163], a[108:111], v[112:115]
    ds_read_b128 v[148:151], v4 offset:29696
    v_mfma_f32_16x16x32_bf16 v[100:103], v[164:167], a[104:107], v[100:103]
    ds_read_b128 v[152:155], v4 offset:30720
    v_mfma_f32_16x16x32_bf16 v[116:119], v[164:167], a[108:111], v[116:119]
    ds_read_b128 v[156:159], v4 offset:31744
    v_mfma_f32_16x16x32_bf16 v[104:107], v[168:171], a[104:107], v[104:107]
    v_mfma_f32_16x16x32_bf16 v[120:123], v[168:171], a[108:111], v[120:123]
    v_mfma_f32_16x16x32_bf16 v[108:111], v[172:175], a[104:107], v[108:111]
    v_mfma_f32_16x16x32_bf16 v[124:127], v[172:175], a[108:111], v[124:127]
    s_waitcnt lgkmcnt(4)
    v_mfma_f32_16x16x32_bf16 v[96:99], v[128:131], a[112:115], v[96:99]
    ds_read_b128 v[160:163], v4 offset:32768
    v_mfma_f32_16x16x32_bf16 v[112:115], v[128:131], a[116:119], v[112:115]
    ds_read_b128 v[164:167], v4 offset:33792
    v_mfma_f32_16x16x32_bf16 v[100:103], v[132:135], a[112:115], v[100:103]
    ds_read_b128 v[168:171], v4 offset:34816
    v_mfma_f32_16x16x32_bf16 v[116:119], v[132:135], a[116:119], v[116:119]
    ds_read_b128 v[172:175], v4 offset:35840
    v_mfma_f32_16x16x32_bf16 v[104:107], v[136:139], a[112:115], v[104:107]
    v_mfma_f32_16x16x32_bf16 v[120:123], v[136:139], a[116:119], v[120:123]
    v_mfma_f32_16x16x32_bf16 v[108:111], v[140:143], a[112:115], v[108:111]
    v_mfma_f32_16x16x32_bf16 v[124:127], v[140:143], a[116:119], v[124:127]
    s_waitcnt lgkmcnt(4)
    v_mfma_f32_16x16x32_bf16 v[96:99], v[144:147], a[120:123], v[96:99]
    ds_read_b128 v[128:131], v4 offset:36864
    v_mfma_f32_16x16x32_bf16 v[112:115], v[144:147], a[124:127], v[112:115]
    ds_read_b128 v[132:135], v4 offset:37888
    v_mfma_f32_16x16x32_bf16 v[100:103], v[148:151], a[120:123], v[100:103]
    ds_read_b128 v[136:139], v4 offset:38912
    v_mfma_f32_16x16x32_bf16 v[116:119], v[148:151], a[124:127], v[116:119]
    ds_read_b128 v[140:143], v4 offset:39936
    v_mfma_f32_16x16x32_bf16 v[104:107], v[152:155], a[120:123], v[104:107]
    v_mfma_f32_16x16x32_bf16 v[120:123], v[152:155], a[124:127], v[120:123]
    v_mfma_f32_16x16x32_bf16 v[108:111], v[156:159], a[120:123], v[108:111]
    v_mfma_f32_16x16x32_bf16 v[124:127], v[156:159], a[124:127], v[124:127]
    ds_read_b128 v[176:179], v18 offset:128
    ds_read_b128 v[180:183], v18 offset:144
    ds_read_b128 v[184:187], v18 offset:512
    ds_read_b128 v[188:191], v18 offset:528
    ds_read_b128 v[192:195], v18 offset:896
    ds_read_b128 v[196:199], v18 offset:912
    ds_read_b128 v[200:203], v18 offset:1280
    ds_read_b128 v[204:207], v18 offset:1296
    s_waitcnt lgkmcnt(0)
    s_waitcnt vmcnt(2)
    s_barrier
    s_cmp_eq_u32 s3, 0
    s_cselect_b32 s6, s68, 0x7f000000
    s_mov_b64 exec, 1
    v_mov_b32 v5, 1
    v_mov_b32 v6, 768
    buffer_atomic_add v5, v6, s[48:51], s6 offen
    s_mov_b64 exec, -1
    s_waitcnt lgkmcnt(4)
    v_mfma_f32_16x16x32_bf16 v[64:67], v[160:163], a[0:3], 0
    ds_read_b128 v[144:147], v4 offset:40960
    v_fma_f32 v96, -v26, v176, v96
    v_fma_f32 v104, -v26, v192, v104
    v_mfma_f32_16x16x32_bf16 v[80:83], v[160:163], a[4:7], 0
    ds_read_b128 v[148:151], v4 offset:41984
    v_fma_f32 v97, -v26, v177, v97
    v_fma_f32 v105, -v26, v193, v105
    v_mfma_f32_16x16x32_bf16 v[68:71], v[164:167], a[0:3], 0
    ds_read_b128 v[152:155], v4 offset:43008
    v_fma_f32 v98, -v26, v178, v98
    v_fma_f32 v106, -v26, v194, v106
    v_mfma_f32_16x16x32_bf16 v[84:87], v[164:167], a[4:7], 0
    ds_read_b128 v[156:159], v4 offset:44032
    v_fma_f32 v99, -v26, v179, v99
    v_fma_f32 v107, -v26, v195, v107
    v_mfma_f32_16x16x32_bf16 v[72:75], v[168:171], a[0:3], 0
    s_cmp_ge_u32 s55, 44032
    s_cselect_b32 s63, 0x7f000000, s55
    buffer_load_dwordx4 a[176:179], v9, s[48:51], s63 offen sc1
    v_mfma_f32_16x16x32_bf16 v[88:91], v[168:171], a[4:7], 0
    v_fma_f32 v100, -v26, v180, v100
    v_fma_f32 v108, -v26, v196, v108
    v_fma_f32 v101, -v26, v181, v101
    v_mfma_f32_16x16x32_bf16 v[76:79], v[172:175], a[0:3], 0
    s_add_u32 s79, s63, 44032
    buffer_load_dwordx4 a[180:183], v9, s[48:51], s79 offen sc1
    v_mfma_f32_16x16x32_bf16 v[92:95], v[172:175], a[4:7], 0
    v_fma_f32 v109, -v26, v197, v109
    v_fma_f32 v102, -v26, v182, v102
    v_fma_f32 v110, -v26, v198, v110
    s_waitcnt lgkmcnt(4)
    v_mfma_f32_16x16x32_bf16 v[64:67], v[128:131], a[8:11], v[64:67]
    ds_read_b128 v[160:163], v4 offset:45056
    v_fma_f32 v103, -v26, v183, v103
    v_fma_f32 v111, -v26, v199, v111
    v_mfma_f32_16x16x32_bf16 v[80:83], v[128:131], a[12:15], v[80:83]
    ds_read_b128 v[164:167], v4 offset:46080
    v_fma_f32 v96, v96, v27, v184
    v_fma_f32 v104, v104, v30, v200
    v_mfma_f32_16x16x32_bf16 v[68:71], v[132:135], a[8:11], v[68:71]
    ds_read_b128 v[168:171], v4 offset:47104
    v_fma_f32 v97, v97, v27, v185
    v_fma_f32 v105, v105, v30, v201
    v_mfma_f32_16x16x32_bf16 v[84:87], v[132:135], a[12:15], v[84:87]
    ds_read_b128 v[172:175], v4 offset:48128
    v_fma_f32 v98, v98, v27, v186
    v_fma_f32 v106, v106, v30, v202
    v_mfma_f32_16x16x32_bf16 v[72:75], v[136:139], a[8:11], v[72:75]
    s_add_u32 s79, s63, 88064
    buffer_load_dwordx4 a[184:187], v9, s[48:51], s79 offen sc1
    v_mfma_f32_16x16x32_bf16 v[88:91], v[136:139], a[12:15], v[88:91]
    v_fma_f32 v99, v99, v27, v187
    v_fma_f32 v107, v107, v30, v203
    v_fma_f32 v100, v100, v27, v188
    v_mfma_f32_16x16x32_bf16 v[76:79], v[140:143], a[8:11], v[76:79]
    s_add_u32 s79, s63, 132096
    buffer_load_dwordx4 a[188:191], v9, s[48:51], s79 offen sc1
    v_mfma_f32_16x16x32_bf16 v[92:95], v[140:143], a[12:15], v[92:95]
    v_fma_f32 v108, v108, v30, v204
    v_fma_f32 v101, v101, v27, v189
    v_fma_f32 v109, v109, v30, v205
    s_waitcnt lgkmcnt(4)
    v_mfma_f32_16x16x32_bf16 v[64:67], v[144:147], a[16:19], v[64:67]
    ds_read_b128 v[128:131], v16 offset:32768
    v_fma_f32 v102, v102, v27, v190
    v_fma_f32 v110, v110, v30, v206
    v_mfma_f32_16x16x32_bf16 v[80:83], v[144:147], a[20:23], v[80:83]
    ds_read_b128 v[132:135], v16 offset:33792
    v_fma_f32 v103, v103, v27, v191
    v_fma_f32 v111, v111, v30, v207
    v_mfma_f32_16x16x32_bf16 v[68:71], v[148:151], a[16:19], v[68:71]
    ds_read_b128 v[136:139], v16 offset:34816
    v_exp_f32 v208, v96
    v_mul_f32 v96, v96, v104
    v_mfma_f32_16x16x32_bf16 v[84:87], v[148:151], a[20:23], v[84:87]
    ds_read_b128 v[140:143], v16 offset:35840
    v_exp_f32 v209, v97
    v_mul_f32 v97, v97, v105
    v_mfma_f32_16x16x32_bf16 v[72:75], v[152:155], a[16:19], v[72:75]
    s_cmp_ge_u32 s56, 44032
    s_cselect_b32 s63, 0x7f000000, s56
    buffer_load_dwordx4 a[192:195], v9, s[48:51], s63 offen sc1
    v_mfma_f32_16x16x32_bf16 v[88:91], v[152:155], a[20:23], v[88:91]
    v_exp_f32 v210, v98
    v_mul_f32 v98, v98, v106
    v_exp_f32 v211, v99
    v_mfma_f32_16x16x32_bf16 v[76:79], v[156:159], a[16:19], v[76:79]
    s_add_u32 s79, s63, 44032
    buffer_load_dwordx4 a[196:199], v9, s[48:51], s79 offen sc1
    v_mfma_f32_16x16x32_bf16 v[92:95], v[156:159], a[20:23], v[92:95]
    v_mul_f32 v99, v99, v107
    v_exp_f32 v212, v100
    v_mul_f32 v100, v100, v108
    s_waitcnt lgkmcnt(4)
    v_mfma_f32_16x16x32_bf16 v[64:67], v[160:163], a[24:27], v[64:67]
    ds_read_b128 v[144:147], v16 offset:36864
    v_exp_f32 v213, v101
    v_mul_f32 v101, v101, v109
    v_mfma_f32_16x16x32_bf16 v[80:83], v[160:163], a[28:31], v[80:83]
    ds_read_b128 v[148:151], v16 offset:37888
    v_exp_f32 v214, v102
    v_mul_f32 v102, v102, v110
    v_mfma_f32_16x16x32_bf16 v[68:71], v[164:167], a[24:27], v[68:71]
    ds_read_b128 v[152:155], v16 offset:38912
    v_exp_f32 v215, v103
    v_mul_f32 v103, v103, v111
    v_mfma_f32_16x16x32_bf16 v[84:87], v[164:167], a[28:31], v[84:87]
    ds_read_b128 v[156:159], v16 offset:39936
    v_add_f32 v208, 1.0, v208
    v_add_f32 v209, 1.0, v209
    v_mfma_f32_16x16x32_bf16 v[72:75], v[168:171], a[24:27], v[72:75]
    s_add_u32 s79, s63, 88064
    buffer_load_dwordx4 a[200:203], v9, s[48:51], s79 offen sc1
    v_mfma_f32_16x16x32_bf16 v[88:91], v[168:171], a[28:31], v[88:91]
    v_add_f32 v210, 1.0, v210
    v_add_f32 v211, 1.0, v211
    v_add_f32 v212, 1.0, v212
    v_mfma_f32_16x16x32_bf16 v[76:79], v[172:175], a[24:27], v[76:79]
    s_add_u32 s79, s63, 132096
    buffer_load_dwordx4 a[204:207], v9, s[48:51], s79 offen sc1
    v_mfma_f32_16x16x32_bf16 v[92:95], v[172:175], a[28:31], v[92:95]
    v_add_f32 v213, 1.0, v213
    v_add_f32 v214, 1.0, v214
    v_add_f32 v215, 1.0, v215
    s_waitcnt lgkmcnt(4)
    v_mfma_f32_16x16x32_bf16 v[64:67], v[128:131], a[32:35], v[64:67]
    ds_read_b128 v[160:163], v16 offset:40960
    v_rcp_f32 v208, v208
    v_rcp_f32 v209, v209
    v_mfma_f32_16x16x32_bf16 v[80:83], v[128:131], a[36:39], v[80:83]
    ds_read_b128 v[164:167], v16 offset:41984
    v_rcp_f32 v210, v210
    v_rcp_f32 v211, v211
    v_mfma_f32_16x16x32_bf16 v[68:71], v[132:135], a[32:35], v[68:71]
    ds_read_b128 v[168:171], v16 offset:43008
    v_rcp_f32 v212, v212
    v_rcp_f32 v213, v213
    v_mfma_f32_16x16x32_bf16 v[84:87], v[132:135], a[36:39], v[84:87]
    ds_read_b128 v[172:175], v16 offset:44032
    v_rcp_f32 v214, v214
    v_rcp_f32 v215, v215
    v_mfma_f32_16x16x32_bf16 v[72:75], v[136:139], a[32:35], v[72:75]
    s_cmp_ge_u32 s57, 44032
    s_cselect_b32 s63, 0x7f000000, s57
    buffer_load_dwordx4 a[208:211], v9, s[48:51], s63 offen sc1
    v_mfma_f32_16x16x32_bf16 v[88:91], v[136:139], a[36:39], v[88:91]
    v_mul_f32 v208, v208, v96
    v_mul_f32 v209, v209, v97
    v_mul_f32 v210, v210, v98
    v_mfma_f32_16x16x32_bf16 v[76:79], v[140:143], a[32:35], v[76:79]
    s_add_u32 s79, s63, 44032
    buffer_load_dwordx4 a[212:215], v9, s[48:51], s79 offen sc1
    v_mfma_f32_16x16x32_bf16 v[92:95], v[140:143], a[36:39], v[92:95]
    v_mul_f32 v211, v211, v99
    v_mul_f32 v212, v212, v100
    v_mul_f32 v213, v213, v101
    s_waitcnt lgkmcnt(4)
    v_mfma_f32_16x16x32_bf16 v[64:67], v[144:147], a[40:43], v[64:67]
    ds_read_b128 v[128:131], v16 offset:45056
    v_mul_f32 v214, v214, v102
    v_mul_f32 v215, v215, v103
    v_mfma_f32_16x16x32_bf16 v[80:83], v[144:147], a[44:47], v[80:83]
    ds_read_b128 v[132:135], v16 offset:46080
    v_cvt_pk_bf16_f32 v224, v208, v209
    v_cvt_pk_bf16_f32 v225, v210, v211
    v_mfma_f32_16x16x32_bf16 v[68:71], v[148:151], a[40:43], v[68:71]
    ds_read_b128 v[136:139], v16 offset:47104
    v_cvt_pk_bf16_f32 v226, v212, v213
    v_cvt_pk_bf16_f32 v227, v214, v215
    v_mfma_f32_16x16x32_bf16 v[84:87], v[148:151], a[44:47], v[84:87]
    ds_read_b128 v[140:143], v16 offset:48128
    buffer_store_dwordx4 v[224:227], v23, s[48:51], 0 offen offset:1024 sc1
    v_fma_f32 v112, -v28, v176, v112
    v_mfma_f32_16x16x32_bf16 v[72:75], v[152:155], a[40:43], v[72:75]
    s_add_u32 s79, s63, 88064
    buffer_load_dwordx4 a[216:219], v9, s[48:51], s79 offen sc1
    v_mfma_f32_16x16x32_bf16 v[88:91], v[152:155], a[44:47], v[88:91]
    v_fma_f32 v120, -v28, v192, v120
    v_fma_f32 v113, -v28, v177, v113
    v_fma_f32 v121, -v28, v193, v121
    v_mfma_f32_16x16x32_bf16 v[76:79], v[156:159], a[40:43], v[76:79]
    s_add_u32 s79, s63, 132096
    buffer_load_dwordx4 a[220:223], v9, s[48:51], s79 offen sc1
    v_mfma_f32_16x16x32_bf16 v[92:95], v[156:159], a[44:47], v[92:95]
    v_fma_f32 v114, -v28, v178, v114
    v_fma_f32 v122, -v28, v194, v122
    v_fma_f32 v115, -v28, v179, v115
    s_waitcnt lgkmcnt(4)
    v_mfma_f32_16x16x32_bf16 v[64:67], v[160:163], a[48:51], v[64:67]
    ds_read_b128 v[144:147], v16 offset:49152
    v_fma_f32 v123, -v28, v195, v123
    v_fma_f32 v116, -v28, v180, v116
    v_mfma_f32_16x16x32_bf16 v[80:83], v[160:163], a[52:55], v[80:83]
    ds_read_b128 v[148:151], v16 offset:50176
    v_fma_f32 v124, -v28, v196, v124
    v_fma_f32 v117, -v28, v181, v117
    v_mfma_f32_16x16x32_bf16 v[68:71], v[164:167], a[48:51], v[68:71]
    ds_read_b128 v[152:155], v16 offset:51200
    v_fma_f32 v125, -v28, v197, v125
    v_fma_f32 v118, -v28, v182, v118
    v_mfma_f32_16x16x32_bf16 v[84:87], v[164:167], a[52:55], v[84:87]
    ds_read_b128 v[156:159], v16 offset:52224
    v_fma_f32 v126, -v28, v198, v126
    v_fma_f32 v119, -v28, v183, v119
    v_mfma_f32_16x16x32_bf16 v[72:75], v[168:171], a[48:51], v[72:75]
    s_cmp_ge_u32 s58, 44032
    s_cselect_b32 s63, 0x7f000000, s58
    buffer_load_dwordx4 a[224:227], v9, s[48:51], s63 offen sc1
    v_mfma_f32_16x16x32_bf16 v[88:91], v[168:171], a[52:55], v[88:91]
    v_fma_f32 v127, -v28, v199, v127
    v_fma_f32 v112, v112, v29, v184
    v_fma_f32 v120, v120, v32, v200
    v_mfma_f32_16x16x32_bf16 v[76:79], v[172:175], a[48:51], v[76:79]
    s_add_u32 s79, s63, 44032
    buffer_load_dwordx4 a[228:231], v9, s[48:51], s79 offen sc1
    v_mfma_f32_16x16x32_bf16 v[92:95], v[172:175], a[52:55], v[92:95]
    v_fma_f32 v113, v113, v29, v185
    v_fma_f32 v121, v121, v32, v201
    v_fma_f32 v114, v114, v29, v186
    s_waitcnt lgkmcnt(4)
    v_mfma_f32_16x16x32_bf16 v[64:67], v[128:131], a[56:59], v[64:67]
    ds_read_b128 v[160:163], v16 offset:53248
    v_fma_f32 v122, v122, v32, v202
    v_fma_f32 v115, v115, v29, v187
    v_mfma_f32_16x16x32_bf16 v[80:83], v[128:131], a[60:63], v[80:83]
    ds_read_b128 v[164:167], v16 offset:54272
    v_fma_f32 v123, v123, v32, v203
    v_fma_f32 v116, v116, v29, v188
    v_mfma_f32_16x16x32_bf16 v[68:71], v[132:135], a[56:59], v[68:71]
    ds_read_b128 v[168:171], v16 offset:55296
    v_fma_f32 v124, v124, v32, v204
    v_fma_f32 v117, v117, v29, v189
    v_mfma_f32_16x16x32_bf16 v[84:87], v[132:135], a[60:63], v[84:87]
    ds_read_b128 v[172:175], v16 offset:56320
    v_fma_f32 v125, v125, v32, v205
    v_fma_f32 v118, v118, v29, v190
    v_mfma_f32_16x16x32_bf16 v[72:75], v[136:139], a[56:59], v[72:75]
    s_add_u32 s79, s63, 88064
    buffer_load_dwordx4 a[232:235], v9, s[48:51], s79 offen sc1
    v_mfma_f32_16x16x32_bf16 v[88:91], v[136:139], a[60:63], v[88:91]
    v_fma_f32 v126, v126, v32, v206
    v_fma_f32 v119, v119, v29, v191
    v_fma_f32 v127, v127, v32, v207
    v_mfma_f32_16x16x32_bf16 v[76:79], v[140:143], a[56:59], v[76:79]
    s_add_u32 s79, s63, 132096
    buffer_load_dwordx4 a[236:239], v9, s[48:51], s79 offen sc1
    v_mfma_f32_16x16x32_bf16 v[92:95], v[140:143], a[60:63], v[92:95]
    v_exp_f32 v216, v112
    v_mul_f32 v112, v112, v120
    v_exp_f32 v217, v113
    s_waitcnt lgkmcnt(4)
    v_mfma_f32_16x16x32_bf16 v[64:67], v[144:147], a[64:67], v[64:67]
    ds_read_b128 v[128:131], v16 offset:57344
    v_mul_f32 v113, v113, v121
    v_exp_f32 v218, v114
    v_mfma_f32_16x16x32_bf16 v[80:83], v[144:147], a[68:71], v[80:83]
    ds_read_b128 v[132:135], v16 offset:58368
    v_mul_f32 v114, v114, v122
    v_exp_f32 v219, v115
    v_mfma_f32_16x16x32_bf16 v[68:71], v[148:151], a[64:67], v[68:71]
    ds_read_b128 v[136:139], v16 offset:59392
    v_mul_f32 v115, v115, v123
    v_exp_f32 v220, v116
    v_mfma_f32_16x16x32_bf16 v[84:87], v[148:151], a[68:71], v[84:87]
    ds_read_b128 v[140:143], v16 offset:60416
    v_mul_f32 v116, v116, v124
    v_exp_f32 v221, v117
    v_mfma_f32_16x16x32_bf16 v[72:75], v[152:155], a[64:67], v[72:75]
    s_cmp_ge_u32 s59, 44032
    s_cselect_b32 s63, 0x7f000000, s59
    s_add_u32 m0, s70, 65536
    s_nop 0
    buffer_load_dwordx4 v9, s[48:51], s63 offen sc1 lds
    v_mfma_f32_16x16x32_bf16 v[88:91], v[152:155], a[68:71], v[88:91]
    v_mul_f32 v117, v117, v125
    v_exp_f32 v222, v118
    v_mul_f32 v118, v118, v126
    v_mfma_f32_16x16x32_bf16 v[76:79], v[156:159], a[64:67], v[76:79]
    s_add_u32 s79, s63, 44032
    s_add_u32 m0, s70, 66560
    s_nop 0
    buffer_load_dwordx4 v9, s[48:51], s79 offen sc1 lds
    v_mfma_f32_16x16x32_bf16 v[92:95], v[156:159], a[68:71], v[92:95]
    v_exp_f32 v223, v119
    v_mul_f32 v119, v119, v127
    v_add_f32 v216, 1.0, v216
    s_waitcnt lgkmcnt(4)
    v_mfma_f32_16x16x32_bf16 v[64:67], v[160:163], a[72:75], v[64:67]
    ds_read_b128 v[144:147], v16 offset:61440
    v_add_f32 v217, 1.0, v217
    v_add_f32 v218, 1.0, v218
    v_mfma_f32_16x16x32_bf16 v[80:83], v[160:163], a[76:79], v[80:83]
    ds_read_b128 v[148:151], v16 offset:62464
    v_add_f32 v219, 1.0, v219
    v_add_f32 v220, 1.0, v220
    v_mfma_f32_16x16x32_bf16 v[68:71], v[164:167], a[72:75], v[68:71]
    ds_read_b128 v[152:155], v16 offset:63488
    v_add_f32 v221, 1.0, v221
    v_add_f32 v222, 1.0, v222
    v_mfma_f32_16x16x32_bf16 v[84:87], v[164:167], a[76:79], v[84:87]
    ds_read_b128 v[156:159], v16 offset:64512
    v_add_f32 v223, 1.0, v223
    v_rcp_f32 v216, v216
    v_mfma_f32_16x16x32_bf16 v[72:75], v[168:171], a[72:75], v[72:75]
    s_add_u32 s79, s63, 88064
    s_add_u32 m0, s70, 67584
    s_nop 0
    buffer_load_dwordx4 v9, s[48:51], s79 offen sc1 lds
    v_mfma_f32_16x16x32_bf16 v[88:91], v[168:171], a[76:79], v[88:91]
    v_rcp_f32 v217, v217
    v_rcp_f32 v218, v218
    v_rcp_f32 v219, v219
    v_mfma_f32_16x16x32_bf16 v[76:79], v[172:175], a[72:75], v[76:79]
    s_add_u32 s79, s63, 132096
    s_add_u32 m0, s70, 68608
    s_nop 0
    buffer_load_dwordx4 v9, s[48:51], s79 offen sc1 lds
    v_mfma_f32_16x16x32_bf16 v[92:95], v[172:175], a[76:79], v[92:95]
    v_rcp_f32 v220, v220
    v_rcp_f32 v221, v221
    v_rcp_f32 v222, v222
    s_waitcnt lgkmcnt(4)
    v_mfma_f32_16x16x32_bf16 v[64:67], v[128:131], a[80:83], v[64:67]
    ds_read_b128 v[160:163], v17 offset:0
    v_rcp_f32 v223, v223
    v_mul_f32 v216, v216, v112
    v_mfma_f32_16x16x32_bf16 v[80:83], v[128:131], a[84:87], v[80:83]
    ds_read_b128 v[164:167], v17 offset:1024
    v_mul_f32 v217, v217, v113
    v_mul_f32 v218, v218, v114
    v_mfma_f32_16x16x32_bf16 v[68:71], v[132:135], a[80:83], v[68:71]
    ds_read_b128 v[168:171], v17 offset:2048
    v_mul_f32 v219, v219, v115
    v_mul_f32 v220, v220, v116
    v_mfma_f32_16x16x32_bf16 v[84:87], v[132:135], a[84:87], v[84:87]
    ds_read_b128 v[172:175], v17 offset:3072
    v_mul_f32 v221, v221, v117
    v_mul_f32 v222, v222, v118
    v_mfma_f32_16x16x32_bf16 v[72:75], v[136:139], a[80:83], v[72:75]
    s_cmp_ge_u32 s60, 44032
    s_cselect_b32 s63, 0x7f000000, s60
    s_add_u32 m0, s70, 81920
    s_nop 0
    buffer_load_dwordx4 v9, s[48:51], s63 offen sc1 lds
    v_mfma_f32_16x16x32_bf16 v[88:91], v[136:139], a[84:87], v[88:91]
    v_mul_f32 v223, v223, v119
    v_cvt_pk_bf16_f32 v228, v216, v217
    v_cvt_pk_bf16_f32 v229, v218, v219
    v_mfma_f32_16x16x32_bf16 v[76:79], v[140:143], a[80:83], v[76:79]
    s_add_u32 s79, s63, 44032
    s_add_u32 m0, s70, 82944
    s_nop 0
    buffer_load_dwordx4 v9, s[48:51], s79 offen sc1 lds
    v_mfma_f32_16x16x32_bf16 v[92:95], v[140:143], a[84:87], v[92:95]
    v_cvt_pk_bf16_f32 v230, v220, v221
    v_cvt_pk_bf16_f32 v231, v222, v223
    buffer_store_dwordx4 v[228:231], v24, s[48:51], 0 offen offset:1024 sc1
    s_waitcnt lgkmcnt(4)
    v_mfma_f32_16x16x32_bf16 v[64:67], v[144:147], a[88:91], v[64:67]
    ds_read_b128 v[128:131], v17 offset:4096
    v_mfma_f32_16x16x32_bf16 v[80:83], v[144:147], a[92:95], v[80:83]
    ds_read_b128 v[132:135], v17 offset:5120
    v_mfma_f32_16x16x32_bf16 v[68:71], v[148:151], a[88:91], v[68:71]
    ds_read_b128 v[136:139], v17 offset:6144
    v_mfma_f32_16x16x32_bf16 v[84:87], v[148:151], a[92:95], v[84:87]
    ds_read_b128 v[140:143], v17 offset:7168
    v_mfma_f32_16x16x32_bf16 v[72:75], v[152:155], a[88:91], v[72:75]
    s_add_u32 s79, s63, 88064
    s_add_u32 m0, s70, 83968
    s_nop 0
    buffer_load_dwordx4 v9, s[48:51], s79 offen sc1 lds
    v_mfma_f32_16x16x32_bf16 v[88:91], v[152:155], a[92:95], v[88:91]
    v_mfma_f32_16x16x32_bf16 v[76:79], v[156:159], a[88:91], v[76:79]
    s_add_u32 s79, s63, 132096
    s_add_u32 m0, s70, 84992
    s_nop 0
    buffer_load_dwordx4 v9, s[48:51], s79 offen sc1 lds
    v_mfma_f32_16x16x32_bf16 v[92:95], v[156:159], a[92:95], v[92:95]
    s_waitcnt lgkmcnt(4)
    v_mfma_f32_16x16x32_bf16 v[64:67], v[160:163], a[96:99], v[64:67]
    ds_read_b128 v[144:147], v17 offset:8192
    v_mfma_f32_16x16x32_bf16 v[80:83], v[160:163], a[100:103], v[80:83]
    ds_read_b128 v[148:151], v17 offset:9216
    v_mfma_f32_16x16x32_bf16 v[68:71], v[164:167], a[96:99], v[68:71]
    ds_read_b128 v[152:155], v17 offset:10240
    v_mfma_f32_16x16x32_bf16 v[84:87], v[164:167], a[100:103], v[84:87]
    ds_read_b128 v[156:159], v17 offset:11264
    v_mfma_f32_16x16x32_bf16 v[72:75], v[168:171], a[96:99], v[72:75]
    s_cmp_ge_u32 s61, 44032
    s_cselect_b32 s63, 0x7f000000, s61
    s_add_u32 m0, s70, 0
    s_nop 0
    buffer_load_dwordx4 v9, s[48:51], s63 offen sc1 lds
    v_mfma_f32_16x16x32_bf16 v[88:91], v[168:171], a[100:103], v[88:91]
    v_mfma_f32_16x16x32_bf16 v[76:79], v[172:175], a[96:99], v[76:79]
    s_add_u32 s79, s63, 44032
    s_add_u32 m0, s70, 1024
    s_nop 0
    buffer_load_dwordx4 v9, s[48:51], s79 offen sc1 lds
    v_mfma_f32_16x16x32_bf16 v[92:95], v[172:175], a[100:103], v[92:95]
    s_waitcnt lgkmcnt(4)
    v_mfma_f32_16x16x32_bf16 v[64:67], v[128:131], a[104:107], v[64:67]
    ds_read_b128 v[160:163], v17 offset:12288
    v_mfma_f32_16x16x32_bf16 v[80:83], v[128:131], a[108:111], v[80:83]
    ds_read_b128 v[164:167], v17 offset:13312
    v_mfma_f32_16x16x32_bf16 v[68:71], v[132:135], a[104:107], v[68:71]
    ds_read_b128 v[168:171], v17 offset:14336
    v_mfma_f32_16x16x32_bf16 v[84:87], v[132:135], a[108:111], v[84:87]
    ds_read_b128 v[172:175], v17 offset:15360
    v_mfma_f32_16x16x32_bf16 v[72:75], v[136:139], a[104:107], v[72:75]
    s_add_u32 s79, s63, 88064
    s_add_u32 m0, s70, 2048
    s_nop 0
    buffer_load_dwordx4 v9, s[48:51], s79 offen sc1 lds
    v_mfma_f32_16x16x32_bf16 v[88:91], v[136:139], a[108:111], v[88:91]
    v_mfma_f32_16x16x32_bf16 v[76:79], v[140:143], a[104:107], v[76:79]
    s_add_u32 s79, s63, 132096
    s_add_u32 m0, s70, 3072
    s_nop 0
    buffer_load_dwordx4 v9, s[48:51], s79 offen sc1 lds
    v_mfma_f32_16x16x32_bf16 v[92:95], v[140:143], a[108:111], v[92:95]
    s_waitcnt lgkmcnt(4)
    v_mfma_f32_16x16x32_bf16 v[64:67], v[144:147], a[112:115], v[64:67]
    v_mfma_f32_16x16x32_bf16 v[80:83], v[144:147], a[116:119], v[80:83]
    v_mfma_f32_16x16x32_bf16 v[68:71], v[148:151], a[112:115], v[68:71]
    v_mfma_f32_16x16x32_bf16 v[84:87], v[148:151], a[116:119], v[84:87]
    v_mfma_f32_16x16x32_bf16 v[72:75], v[152:155], a[112:115], v[72:75]
    s_cmp_ge_u32 s62, 44032
    s_cselect_b32 s63, 0x7f000000, s62
    s_add_u32 m0, s70, 16384
    s_nop 0
    buffer_load_dwordx4 v9, s[48:51], s63 offen sc1 lds
    v_mfma_f32_16x16x32_bf16 v[88:91], v[152:155], a[116:119], v[88:91]
    v_mfma_f32_16x16x32_bf16 v[76:79], v[156:159], a[112:115], v[76:79]
    s_add_u32 s79, s63, 44032
    s_add_u32 m0, s70, 17408
    s_nop 0
    buffer_load_dwordx4 v9, s[48:51], s79 offen sc1 lds
    v_mfma_f32_16x16x32_bf16 v[92:95], v[156:159], a[116:119], v[92:95]
    s_waitcnt lgkmcnt(0)
    v_mfma_f32_16x16x32_bf16 v[64:67], v[160:163], a[120:123], v[64:67]
    v_mfma_f32_16x16x32_bf16 v[80:83], v[160:163], a[124:127], v[80:83]
    v_mfma_f32_16x16x32_bf16 v[68:71], v[164:167], a[120:123], v[68:71]
    v_mfma_f32_16x16x32_bf16 v[84:87], v[164:167], a[124:127], v[84:87]
    v_mfma_f32_16x16x32_bf16 v[72:75], v[168:171], a[120:123], v[72:75]
    s_add_u32 s79, s63, 88064
    s_add_u32 m0, s70, 18432
    s_nop 0
    buffer_load_dwordx4 v9, s[48:51], s79 offen sc1 lds
    v_mfma_f32_16x16x32_bf16 v[88:91], v[168:171], a[124:127], v[88:91]
    v_mfma_f32_16x16x32_bf16 v[76:79], v[172:175], a[120:123], v[76:79]
    s_add_u32 s79, s63, 132096
    s_add_u32 m0, s70, 19456
    s_nop 0
    buffer_load_dwordx4 v9, s[48:51], s79 offen sc1 lds
    v_mfma_f32_16x16x32_bf16 v[92:95], v[172:175], a[124:127], v[92:95]
    ds_read_b128 v[176:179], v18 offset:256
    ds_read_b128 v[180:183], v18 offset:272
    ds_read_b128 v[184:187], v18 offset:640
    ds_read_b128 v[188:191], v18 offset:656
    ds_read_b128 v[192:195], v18 offset:1024
    ds_read_b128 v[196:199], v18 offset:1040
    ds_read_b128 v[200:203], v18 offset:1408
    ds_read_b128 v[204:207], v18 offset:1424
    s_waitcnt vmcnt(10) lgkmcnt(0)
    s_barrier
    s_cmp_eq_u32 s3, 0
    s_cselect_b32 s6, s68, 0x7f000000
    s_mov_b64 exec, 1
    v_mov_b32 v5, 1
    v_mov_b32 v6, 896
    buffer_atomic_add v5, v6, s[48:51], s6 offen
    s_mov_b64 exec, -1
    v_mov_b32 v6, 768
    buffer_load_dword v7, v6, s[48:51], s68 offen sc1
    v_fma_f32 v64, -v26, v176, v64
    v_fma_f32 v72, -v26, v192, v72
    v_fma_f32 v65, -v26, v177, v65
    v_fma_f32 v73, -v26, v193, v73
    v_fma_f32 v66, -v26, v178, v66
    v_fma_f32 v74, -v26, v194, v74
    v_fma_f32 v67, -v26, v179, v67
    v_fma_f32 v75, -v26, v195, v75
    v_fma_f32 v68, -v26, v180, v68
    v_fma_f32 v76, -v26, v196, v76
    v_fma_f32 v69, -v26, v181, v69
    v_fma_f32 v77, -v26, v197, v77
    v_fma_f32 v70, -v26, v182, v70
    v_fma_f32 v78, -v26, v198, v78
    v_fma_f32 v71, -v26, v183, v71
    v_fma_f32 v79, -v26, v199, v79
    v_fma_f32 v64, v64, v27, v184
    v_fma_f32 v72, v72, v30, v200
    v_fma_f32 v65, v65, v27, v185
    v_fma_f32 v73, v73, v30, v201
    v_fma_f32 v66, v66, v27, v186
    v_fma_f32 v74, v74, v30, v202
    v_fma_f32 v67, v67, v27, v187
    v_fma_f32 v75, v75, v30, v203
    v_fma_f32 v68, v68, v27, v188
    v_fma_f32 v76, v76, v30, v204
    v_fma_f32 v69, v69, v27, v189
    v_fma_f32 v77, v77, v30, v205
    v_fma_f32 v70, v70, v27, v190
    v_fma_f32 v78, v78, v30, v206
    v_fma_f32 v71, v71, v27, v191
    v_fma_f32 v79, v79, v30, v207
    v_exp_f32 v208, v64
    v_mul_f32 v64, v64, v72
    v_exp_f32 v209, v65
    v_mul_f32 v65, v65, v73
    v_exp_f32 v210, v66
    v_mul_f32 v66, v66, v74
    v_exp_f32 v211, v67
    v_mul_f32 v67, v67, v75
    v_exp_f32 v212, v68
    v_mul_f32 v68, v68, v76
    v_exp_f32 v213, v69
    v_mul_f32 v69, v69, v77
    v_exp_f32 v214, v70
    v_mul_f32 v70, v70, v78
    v_exp_f32 v215, v71
    v_mul_f32 v71, v71, v79
    v_add_f32 v208, 1.0, v208
    v_add_f32 v209, 1.0, v209
    v_add_f32 v210, 1.0, v210
    v_add_f32 v211, 1.0, v211
    v_add_f32 v212, 1.0, v212
    v_add_f32 v213, 1.0, v213
    v_add_f32 v214, 1.0, v214
    v_add_f32 v215, 1.0, v215
    v_rcp_f32 v208, v208
    v_rcp_f32 v209, v209
    v_rcp_f32 v210, v210
    v_rcp_f32 v211, v211
    v_rcp_f32 v212, v212
    v_rcp_f32 v213, v213
    v_rcp_f32 v214, v214
    v_rcp_f32 v215, v215
    v_mul_f32 v208, v208, v64
    v_mul_f32 v209, v209, v65
    v_mul_f32 v210, v210, v66
    v_mul_f32 v211, v211, v67
    v_mul_f32 v212, v212, v68
    v_mul_f32 v213, v213, v69
    v_mul_f32 v214, v214, v70
    v_mul_f32 v215, v215, v71
    v_cvt_pk_bf16_f32 v224, v208, v209
    v_cvt_pk_bf16_f32 v225, v210, v211
    v_cvt_pk_bf16_f32 v226, v212, v213
    v_cvt_pk_bf16_f32 v227, v214, v215
    buffer_store_dwordx4 v[224:227], v23, s[48:51], s32 offen offset:2048 sc1
    v_fma_f32 v80, -v28, v176, v80
    v_fma_f32 v88, -v28, v192, v88
    v_fma_f32 v81, -v28, v177, v81
    v_fma_f32 v89, -v28, v193, v89
    v_fma_f32 v82, -v28, v178, v82
    v_fma_f32 v90, -v28, v194, v90
    v_fma_f32 v83, -v28, v179, v83
    v_fma_f32 v91, -v28, v195, v91
    v_fma_f32 v84, -v28, v180, v84
    v_fma_f32 v92, -v28, v196, v92
    v_fma_f32 v85, -v28, v181, v85
    v_fma_f32 v93, -v28, v197, v93
    v_fma_f32 v86, -v28, v182, v86
    v_fma_f32 v94, -v28, v198, v94
    v_fma_f32 v87, -v28, v183, v87
    v_fma_f32 v95, -v28, v199, v95
    v_fma_f32 v80, v80, v29, v184
    v_fma_f32 v88, v88, v32, v200
    v_fma_f32 v81, v81, v29, v185
    v_fma_f32 v89, v89, v32, v201
    v_fma_f32 v82, v82, v29, v186
    v_fma_f32 v90, v90, v32, v202
    v_fma_f32 v83, v83, v29, v187
    v_fma_f32 v91, v91, v32, v203
    v_fma_f32 v84, v84, v29, v188
    v_fma_f32 v92, v92, v32, v204
    v_fma_f32 v85, v85, v29, v189
    v_fma_f32 v93, v93, v32, v205
    v_fma_f32 v86, v86, v29, v190
    v_fma_f32 v94, v94, v32, v206
    v_fma_f32 v87, v87, v29, v191
    v_fma_f32 v95, v95, v32, v207
    v_exp_f32 v216, v80
    v_mul_f32 v80, v80, v88
    v_exp_f32 v217, v81
    v_mul_f32 v81, v81, v89
    v_exp_f32 v218, v82
    v_mul_f32 v82, v82, v90
    v_exp_f32 v219, v83
    v_mul_f32 v83, v83, v91
    v_exp_f32 v220, v84
    v_mul_f32 v84, v84, v92
    v_exp_f32 v221, v85
    v_mul_f32 v85, v85, v93
    v_exp_f32 v222, v86
    v_mul_f32 v86, v86, v94
    v_exp_f32 v223, v87
    v_mul_f32 v87, v87, v95
    v_add_f32 v216, 1.0, v216
    v_add_f32 v217, 1.0, v217
    v_add_f32 v218, 1.0, v218
    v_add_f32 v219, 1.0, v219
    v_add_f32 v220, 1.0, v220
    v_add_f32 v221, 1.0, v221
    v_add_f32 v222, 1.0, v222
    v_add_f32 v223, 1.0, v223
    v_rcp_f32 v216, v216
    v_rcp_f32 v217, v217
    v_rcp_f32 v218, v218
    v_rcp_f32 v219, v219
    v_rcp_f32 v220, v220
    v_rcp_f32 v221, v221
    v_rcp_f32 v222, v222
    v_rcp_f32 v223, v223
    v_mul_f32 v216, v216, v80
    v_mul_f32 v217, v217, v81
    v_mul_f32 v218, v218, v82
    v_mul_f32 v219, v219, v83
    v_mul_f32 v220, v220, v84
    v_mul_f32 v221, v221, v85
    v_mul_f32 v222, v222, v86
    v_mul_f32 v223, v223, v87
    v_cvt_pk_bf16_f32 v228, v216, v217
    v_cvt_pk_bf16_f32 v229, v218, v219
    v_cvt_pk_bf16_f32 v230, v220, v221
    v_cvt_pk_bf16_f32 v231, v222, v223
    buffer_store_dwordx4 v[228:231], v24, s[48:51], s32 offen offset:2048 sc1
    s_lshr_b32 s6, s66, 4
    s_add_u32 s7, s3, 0
    s_and_b32 s7, s7, 3
    s_add_u32 s7, s7, s6
    s_mul_i32 s7, s7, 44032
    s_add_u32 s7, s7, 11534336
    v_add_u32 v20, s7, v4
    s_add_u32 s7, s3, 1
    s_and_b32 s7, s7, 3
    s_add_u32 s7, s7, s6
    s_mul_i32 s7, s7, 44032
    s_add_u32 s7, s7, 11534336
    v_add_u32 v21, s7, v4
    s_add_u32 s7, s3, 2
    s_and_b32 s7, s7, 3
    s_add_u32 s7, s7, s6
    s_mul_i32 s7, s7, 44032
    s_add_u32 s7, s7, 11534336
    v_add_u32 v22, s7, v4
    s_add_u32 s7, s3, 3
    s_and_b32 s7, s7, 3
    s_add_u32 s7, s7, s6
    s_mul_i32 s7, s7, 44032
    s_add_u32 s7, s7, 11534336
    v_add_u32 v23, s7, v4
    s_waitcnt vmcnt(2)
    v_cmp_gt_u32 vcc, 16, v7
    s_nop 4
    s_cbranch_vccz CK_31
    s_mov_b64 exec, 1
    v_mov_b32 v6, 768
    s_mov_b32 s90, 0
    s_nop 3
P_32:
    buffer_load_dword v5, v6, s[48:51], s68 offen sc1
    s_add_u32 s90, s90, 1
    s_cmp_gt_u32 s90, 400000
    s_nop 1
    s_cbranch_scc1 P_33
    s_waitcnt vmcnt(0)
    v_cmp_gt_u32 vcc, 16, v5
    s_nop 4
    s_cbranch_vccnz P_32
    s_nop 1
P_33:
    s_mov_b64 exec, -1
    s_nop 1
CK_31:
    s_min_u32 s35, s52, 43008
    buffer_load_dwordx4 a[0:3], v20, s[48:51], s35 offen sc1
    buffer_load_dwordx4 a[4:7], v21, s[48:51], s35 offen sc1
    buffer_load_dwordx4 a[8:11], v22, s[48:51], s35 offen sc1
    buffer_load_dwordx4 a[12:15], v23, s[48:51], s35 offen sc1
    s_min_u32 s35, s53, 43008
    buffer_load_dwordx4 a[16:19], v20, s[48:51], s35 offen sc1
    buffer_load_dwordx4 a[20:23], v21, s[48:51], s35 offen sc1
    buffer_load_dwordx4 a[24:27], v22, s[48:51], s35 offen sc1
    buffer_load_dwordx4 a[28:31], v23, s[48:51], s35 offen sc1
    s_min_u32 s35, s54, 43008
    buffer_load_dwordx4 a[32:35], v20, s[48:51], s35 offen sc1
    buffer_load_dwordx4 a[36:39], v21, s[48:51], s35 offen sc1
    buffer_load_dwordx4 a[40:43], v22, s[48:51], s35 offen sc1
    buffer_load_dwordx4 a[44:47], v23, s[48:51], s35 offen sc1
    s_min_u32 s35, s55, 43008
    buffer_load_dwordx4 a[48:51], v20, s[48:51], s35 offen sc1
    buffer_load_dwordx4 a[52:55], v21, s[48:51], s35 offen sc1
    buffer_load_dwordx4 a[56:59], v22, s[48:51], s35 offen sc1
    buffer_load_dwordx4 a[60:63], v23, s[48:51], s35 offen sc1
    v_mov_b32 v6, 896
    buffer_load_dword v7, v6, s[48:51], s68 offen sc1
    s_waitcnt vmcnt(17)
    s_barrier
    s_cmp_eq_u32 s3, 0
    s_cselect_b32 s6, s68, 0x7f000000
    s_mov_b64 exec, 1
    v_mov_b32 v5, 1
    v_mov_b32 v6, 384
    buffer_atomic_add v5, v6, s[48:51], s6 offen
    s_mov_b64 exec, -1
    s_lshl_b32 s34, s3, 4
    s_add_u32 s34, s34, s66
    v_add_u32 v24, s34, v2
    v_lshlrev_b32 v25, 10, v24
    v_lshl_add_u32 v25, v3, 4, v25
    v_add_u32 v16, s70, v4
    s_waitcnt vmcnt(1)
    v_cmp_gt_u32 vcc, 16, v7
    s_nop 4
    s_cbranch_vccz CK_34
    s_mov_b64 exec, 1
    v_mov_b32 v6, 896
    s_mov_b32 s90, 0
    s_nop 3
P_35:
    buffer_load_dword v5, v6, s[48:51], s68 offen sc1
    s_add_u32 s90, s90, 1
    s_cmp_gt_u32 s90, 400000
    s_nop 1
    s_cbranch_scc1 P_36
    s_waitcnt vmcnt(0)
    v_cmp_gt_u32 vcc, 16, v5
    s_nop 4
    s_cbranch_vccnz P_35
    s_nop 1
P_36:
    s_mov_b64 exec, -1
    s_nop 1
CK_34:
    s_waitcnt vmcnt(14)
    v_mfma_f32_16x16x32_bf16 v[64:67], a[128:131], a[0:3], 0
    v_mfma_f32_16x16x32_bf16 v[68:71], a[132:135], a[0:3], 0
    s_min_u32 s35, s56, 43008
    buffer_load_dwordx4 a[64:67], v20, s[48:51], s35 offen sc1
    v_mfma_f32_16x16x32_bf16 v[72:75], a[136:139], a[0:3], 0
    v_mfma_f32_16x16x32_bf16 v[76:79], a[140:143], a[0:3], 0
    buffer_load_dwordx4 a[68:71], v21, s[48:51], s35 offen sc1
    v_mfma_f32_16x16x32_bf16 v[80:83], a[128:131], a[4:7], 0
    v_mfma_f32_16x16x32_bf16 v[84:87], a[132:135], a[4:7], 0
    buffer_load_dwordx4 a[72:75], v22, s[48:51], s35 offen sc1
    v_mfma_f32_16x16x32_bf16 v[88:91], a[136:139], a[4:7], 0
    v_mfma_f32_16x16x32_bf16 v[92:95], a[140:143], a[4:7], 0
    buffer_load_dwordx4 a[76:79], v23, s[48:51], s35 offen sc1
    v_mfma_f32_16x16x32_bf16 v[96:99], a[128:131], a[8:11], 0
    v_mfma_f32_16x16x32_bf16 v[100:103], a[132:135], a[8:11], 0
    v_mfma_f32_16x16x32_bf16 v[104:107], a[136:139], a[8:11], 0
    v_mfma_f32_16x16x32_bf16 v[108:111], a[140:143], a[8:11], 0
    v_mfma_f32_16x16x32_bf16 v[112:115], a[128:131], a[12:15], 0
    v_mfma_f32_16x16x32_bf16 v[116:119], a[132:135], a[12:15], 0
    v_mfma_f32_16x16x32_bf16 v[120:123], a[136:139], a[12:15], 0
    v_mfma_f32_16x16x32_bf16 v[124:127], a[140:143], a[12:15], 0
    s_waitcnt vmcnt(14)
    v_add_u32 v17, 0x10000, v16
    ds_read_b128 v[176:179], v17 offset:0
    ds_read_b128 v[180:183], v17 offset:1024
    ds_read_b128 v[184:187], v17 offset:2048
    ds_read_b128 v[188:191], v17 offset:3072
    ds_read_b128 v[192:195], v17 offset:16384
    ds_read_b128 v[196:199], v17 offset:17408
    ds_read_b128 v[200:203], v17 offset:18432
    ds_read_b128 v[204:207], v17 offset:19456
    ds_read_b128 v[208:211], v16 offset:0
    ds_read_b128 v[212:215], v16 offset:1024
    ds_read_b128 v[216:219], v16 offset:2048
    ds_read_b128 v[220:223], v16 offset:3072
    ds_read_b128 v[224:227], v16 offset:16384
    ds_read_b128 v[228:231], v16 offset:17408
    ds_read_b128 v[232:235], v16 offset:18432
    ds_read_b128 v[236:239], v16 offset:19456
    v_mfma_f32_16x16x32_bf16 v[64:67], a[144:147], a[16:19], v[64:67]
    v_mfma_f32_16x16x32_bf16 v[68:71], a[148:151], a[16:19], v[68:71]
    s_min_u32 s35, s57, 43008
    buffer_load_dwordx4 a[80:83], v20, s[48:51], s35 offen sc1
    v_mfma_f32_16x16x32_bf16 v[72:75], a[152:155], a[16:19], v[72:75]
    v_mfma_f32_16x16x32_bf16 v[76:79], a[156:159], a[16:19], v[76:79]
    buffer_load_dwordx4 a[84:87], v21, s[48:51], s35 offen sc1
    v_mfma_f32_16x16x32_bf16 v[80:83], a[144:147], a[20:23], v[80:83]
    v_mfma_f32_16x16x32_bf16 v[84:87], a[148:151], a[20:23], v[84:87]
    buffer_load_dwordx4 a[88:91], v22, s[48:51], s35 offen sc1
    v_mfma_f32_16x16x32_bf16 v[88:91], a[152:155], a[20:23], v[88:91]
    v_mfma_f32_16x16x32_bf16 v[92:95], a[156:159], a[20:23], v[92:95]
    buffer_load_dwordx4 a[92:95], v23, s[48:51], s35 offen sc1
    v_mfma_f32_16x16x32_bf16 v[96:99], a[144:147], a[24:27], v[96:99]
    v_mfma_f32_16x16x32_bf16 v[100:103], a[148:151], a[24:27], v[100:103]
    v_mfma_f32_16x16x32_bf16 v[104:107], a[152:155], a[24:27], v[104:107]
    v_mfma_f32_16x16x32_bf16 v[108:111], a[156:159], a[24:27], v[108:111]
    v_mfma_f32_16x16x32_bf16 v[112:115], a[144:147], a[28:31], v[112:115]
    v_mfma_f32_16x16x32_bf16 v[116:119], a[148:151], a[28:31], v[116:119]
    v_mfma_f32_16x16x32_bf16 v[120:123], a[152:155], a[28:31], v[120:123]
    v_mfma_f32_16x16x32_bf16 v[124:127], a[156:159], a[28:31], v[124:127]
    s_waitcnt vmcnt(14)
    v_mfma_f32_16x16x32_bf16 v[64:67], a[160:163], a[32:35], v[64:67]
    v_mfma_f32_16x16x32_bf16 v[68:71], a[164:167], a[32:35], v[68:71]
    s_min_u32 s35, s58, 43008
    buffer_load_dwordx4 a[96:99], v20, s[48:51], s35 offen sc1
    v_mfma_f32_16x16x32_bf16 v[72:75], a[168:171], a[32:35], v[72:75]
    v_mfma_f32_16x16x32_bf16 v[76:79], a[172:175], a[32:35], v[76:79]
    buffer_load_dwordx4 a[100:103], v21, s[48:51], s35 offen sc1
    v_mfma_f32_16x16x32_bf16 v[80:83], a[160:163], a[36:39], v[80:83]
    v_mfma_f32_16x16x32_bf16 v[84:87], a[164:167], a[36:39], v[84:87]
    buffer_load_dwordx4 a[104:107], v22, s[48:51], s35 offen sc1
    v_mfma_f32_16x16x32_bf16 v[88:91], a[168:171], a[36:39], v[88:91]
    v_mfma_f32_16x16x32_bf16 v[92:95], a[172:175], a[36:39], v[92:95]
    buffer_load_dwordx4 a[108:111], v23, s[48:51], s35 offen sc1
    v_mfma_f32_16x16x32_bf16 v[96:99], a[160:163], a[40:43], v[96:99]
    v_mfma_f32_16x16x32_bf16 v[100:103], a[164:167], a[40:43], v[100:103]
    v_mfma_f32_16x16x32_bf16 v[104:107], a[168:171], a[40:43], v[104:107]
    v_mfma_f32_16x16x32_bf16 v[108:111], a[172:175], a[40:43], v[108:111]
    v_mfma_f32_16x16x32_bf16 v[112:115], a[160:163], a[44:47], v[112:115]
    v_mfma_f32_16x16x32_bf16 v[116:119], a[164:167], a[44:47], v[116:119]
    v_mfma_f32_16x16x32_bf16 v[120:123], a[168:171], a[44:47], v[120:123]
    v_mfma_f32_16x16x32_bf16 v[124:127], a[172:175], a[44:47], v[124:127]
    v_mov_b32 v6, 384
    buffer_load_dword v7, v6, s[48:51], s68 offen sc1
    s_waitcnt vmcnt(15)
    v_mfma_f32_16x16x32_bf16 v[64:67], a[176:179], a[48:51], v[64:67]
    v_mfma_f32_16x16x32_bf16 v[68:71], a[180:183], a[48:51], v[68:71]
    s_min_u32 s35, s59, 43008
    buffer_load_dwordx4 a[112:115], v20, s[48:51], s35 offen sc1
    v_mfma_f32_16x16x32_bf16 v[72:75], a[184:187], a[48:51], v[72:75]
    v_mfma_f32_16x16x32_bf16 v[76:79], a[188:191], a[48:51], v[76:79]
    buffer_load_dwordx4 a[116:119], v21, s[48:51], s35 offen sc1
    v_mfma_f32_16x16x32_bf16 v[80:83], a[176:179], a[52:55], v[80:83]
    v_mfma_f32_16x16x32_bf16 v[84:87], a[180:183], a[52:55], v[84:87]
    buffer_load_dwordx4 a[120:123], v22, s[48:51], s35 offen sc1
    v_mfma_f32_16x16x32_bf16 v[88:91], a[184:187], a[52:55], v[88:91]
    v_mfma_f32_16x16x32_bf16 v[92:95], a[188:191], a[52:55], v[92:95]
    buffer_load_dwordx4 a[124:127], v23, s[48:51], s35 offen sc1
    v_mfma_f32_16x16x32_bf16 v[96:99], a[176:179], a[56:59], v[96:99]
    v_mfma_f32_16x16x32_bf16 v[100:103], a[180:183], a[56:59], v[100:103]
    v_mfma_f32_16x16x32_bf16 v[104:107], a[184:187], a[56:59], v[104:107]
    v_mfma_f32_16x16x32_bf16 v[108:111], a[188:191], a[56:59], v[108:111]
    v_mfma_f32_16x16x32_bf16 v[112:115], a[176:179], a[60:63], v[112:115]
    v_mfma_f32_16x16x32_bf16 v[116:119], a[180:183], a[60:63], v[116:119]
    v_mfma_f32_16x16x32_bf16 v[120:123], a[184:187], a[60:63], v[120:123]
    v_mfma_f32_16x16x32_bf16 v[124:127], a[188:191], a[60:63], v[124:127]
    s_waitcnt vmcnt(4)
    v_cmp_gt_u32 vcc, 16, v7
    s_nop 5
    s_cbranch_vccz CK_37
    s_mov_b64 exec, 1
    v_mov_b32 v6, 384
    s_mov_b32 s90, 0
    s_nop 3
P_38:
    buffer_load_dword v5, v6, s[48:51], s68 offen sc1
    s_add_u32 s90, s90, 1
    s_cmp_gt_u32 s90, 400000
    s_nop 1
    s_cbranch_scc1 P_39
    s_waitcnt vmcnt(0)
    v_cmp_gt_u32 vcc, 16, v5
    s_nop 4
    s_cbranch_vccnz P_38
    s_nop 1
P_39:
    s_mov_b64 exec, -1
    s_nop 1
CK_37:
    s_waitcnt vmcnt(13)
    v_mfma_f32_16x16x32_bf16 v[64:67], a[192:195], a[64:67], v[64:67]
    v_mfma_f32_16x16x32_bf16 v[68:71], a[196:199], a[64:67], v[68:71]
    s_min_u32 s35, s60, 43008
    buffer_load_dwordx4 v[128:131], v20, s[48:51], s35 offen sc1
    v_mfma_f32_16x16x32_bf16 v[72:75], a[200:203], a[64:67], v[72:75]
    v_mfma_f32_16x16x32_bf16 v[76:79], a[204:207], a[64:67], v[76:79]
    buffer_load_dwordx4 v[132:135], v21, s[48:51], s35 offen sc1
    v_mfma_f32_16x16x32_bf16 v[80:83], a[192:195], a[68:71], v[80:83]
    v_mfma_f32_16x16x32_bf16 v[84:87], a[196:199], a[68:71], v[84:87]
    buffer_load_dwordx4 v[136:139], v22, s[48:51], s35 offen sc1
    v_mfma_f32_16x16x32_bf16 v[88:91], a[200:203], a[68:71], v[88:91]
    v_mfma_f32_16x16x32_bf16 v[92:95], a[204:207], a[68:71], v[92:95]
    buffer_load_dwordx4 v[140:143], v23, s[48:51], s35 offen sc1
    v_mfma_f32_16x16x32_bf16 v[96:99], a[192:195], a[72:75], v[96:99]
    v_mfma_f32_16x16x32_bf16 v[100:103], a[196:199], a[72:75], v[100:103]
    v_mfma_f32_16x16x32_bf16 v[104:107], a[200:203], a[72:75], v[104:107]
    v_mfma_f32_16x16x32_bf16 v[108:111], a[204:207], a[72:75], v[108:111]
    v_mfma_f32_16x16x32_bf16 v[112:115], a[192:195], a[76:79], v[112:115]
    v_mfma_f32_16x16x32_bf16 v[116:119], a[196:199], a[76:79], v[116:119]
    v_mfma_f32_16x16x32_bf16 v[120:123], a[200:203], a[76:79], v[120:123]
    v_mfma_f32_16x16x32_bf16 v[124:127], a[204:207], a[76:79], v[124:127]
    s_waitcnt vmcnt(13)
    v_mfma_f32_16x16x32_bf16 v[64:67], a[208:211], a[80:83], v[64:67]
    v_mfma_f32_16x16x32_bf16 v[68:71], a[212:215], a[80:83], v[68:71]
    s_min_u32 s35, s61, 43008
    buffer_load_dwordx4 v[144:147], v20, s[48:51], s35 offen sc1
    v_mfma_f32_16x16x32_bf16 v[72:75], a[216:219], a[80:83], v[72:75]
    v_mfma_f32_16x16x32_bf16 v[76:79], a[220:223], a[80:83], v[76:79]
    buffer_load_dwordx4 v[148:151], v21, s[48:51], s35 offen sc1
    v_mfma_f32_16x16x32_bf16 v[80:83], a[208:211], a[84:87], v[80:83]
    v_mfma_f32_16x16x32_bf16 v[84:87], a[212:215], a[84:87], v[84:87]
    buffer_load_dwordx4 v[152:155], v22, s[48:51], s35 offen sc1
    v_mfma_f32_16x16x32_bf16 v[88:91], a[216:219], a[84:87], v[88:91]
    v_mfma_f32_16x16x32_bf16 v[92:95], a[220:223], a[84:87], v[92:95]
    buffer_load_dwordx4 v[156:159], v23, s[48:51], s35 offen sc1
    v_mfma_f32_16x16x32_bf16 v[96:99], a[208:211], a[88:91], v[96:99]
    v_mfma_f32_16x16x32_bf16 v[100:103], a[212:215], a[88:91], v[100:103]
    v_mfma_f32_16x16x32_bf16 v[104:107], a[216:219], a[88:91], v[104:107]
    v_mfma_f32_16x16x32_bf16 v[108:111], a[220:223], a[88:91], v[108:111]
    v_mfma_f32_16x16x32_bf16 v[112:115], a[208:211], a[92:95], v[112:115]
    v_mfma_f32_16x16x32_bf16 v[116:119], a[212:215], a[92:95], v[116:119]
    v_mfma_f32_16x16x32_bf16 v[120:123], a[216:219], a[92:95], v[120:123]
    v_mfma_f32_16x16x32_bf16 v[124:127], a[220:223], a[92:95], v[124:127]
    s_waitcnt vmcnt(13)
    v_mfma_f32_16x16x32_bf16 v[64:67], a[224:227], a[96:99], v[64:67]
    v_mfma_f32_16x16x32_bf16 v[68:71], a[228:231], a[96:99], v[68:71]
    s_min_u32 s35, s62, 43008
    buffer_load_dwordx4 v[160:163], v20, s[48:51], s35 offen sc1
    v_mfma_f32_16x16x32_bf16 v[72:75], a[232:235], a[96:99], v[72:75]
    v_mfma_f32_16x16x32_bf16 v[76:79], a[236:239], a[96:99], v[76:79]
    buffer_load_dwordx4 v[164:167], v21, s[48:51], s35 offen sc1
    v_mfma_f32_16x16x32_bf16 v[80:83], a[224:227], a[100:103], v[80:83]
    v_mfma_f32_16x16x32_bf16 v[84:87], a[228:231], a[100:103], v[84:87]
    buffer_load_dwordx4 v[168:171], v22, s[48:51], s35 offen sc1
    v_mfma_f32_16x16x32_bf16 v[88:91], a[232:235], a[100:103], v[88:91]
    v_mfma_f32_16x16x32_bf16 v[92:95], a[236:239], a[100:103], v[92:95]
    buffer_load_dwordx4 v[172:175], v23, s[48:51], s35 offen sc1
    v_mfma_f32_16x16x32_bf16 v[96:99], a[224:227], a[104:107], v[96:99]
    v_mfma_f32_16x16x32_bf16 v[100:103], a[228:231], a[104:107], v[100:103]
    v_mfma_f32_16x16x32_bf16 v[104:107], a[232:235], a[104:107], v[104:107]
    v_mfma_f32_16x16x32_bf16 v[108:111], a[236:239], a[104:107], v[108:111]
    v_mfma_f32_16x16x32_bf16 v[112:115], a[224:227], a[108:111], v[112:115]
    v_mfma_f32_16x16x32_bf16 v[116:119], a[228:231], a[108:111], v[116:119]
    v_mfma_f32_16x16x32_bf16 v[120:123], a[232:235], a[108:111], v[120:123]
    v_mfma_f32_16x16x32_bf16 v[124:127], a[236:239], a[108:111], v[124:127]
    s_waitcnt vmcnt(12)
    s_waitcnt lgkmcnt(0)
    v_mfma_f32_16x16x32_bf16 v[64:67], v[176:179], a[112:115], v[64:67]
    v_mfma_f32_16x16x32_bf16 v[68:71], v[180:183], a[112:115], v[68:71]
    v_mfma_f32_16x16x32_bf16 v[72:75], v[184:187], a[112:115], v[72:75]
    v_mfma_f32_16x16x32_bf16 v[76:79], v[188:191], a[112:115], v[76:79]
    v_mfma_f32_16x16x32_bf16 v[80:83], v[176:179], a[116:119], v[80:83]
    v_mfma_f32_16x16x32_bf16 v[84:87], v[180:183], a[116:119], v[84:87]
    v_mfma_f32_16x16x32_bf16 v[88:91], v[184:187], a[116:119], v[88:91]
    v_mfma_f32_16x16x32_bf16 v[92:95], v[188:191], a[116:119], v[92:95]
    v_mfma_f32_16x16x32_bf16 v[96:99], v[176:179], a[120:123], v[96:99]
    v_mfma_f32_16x16x32_bf16 v[100:103], v[180:183], a[120:123], v[100:103]
    v_mfma_f32_16x16x32_bf16 v[104:107], v[184:187], a[120:123], v[104:107]
    v_mfma_f32_16x16x32_bf16 v[108:111], v[188:191], a[120:123], v[108:111]
    v_mfma_f32_16x16x32_bf16 v[112:115], v[176:179], a[124:127], v[112:115]
    v_mfma_f32_16x16x32_bf16 v[116:119], v[180:183], a[124:127], v[116:119]
    v_mfma_f32_16x16x32_bf16 v[120:123], v[184:187], a[124:127], v[120:123]
    v_mfma_f32_16x16x32_bf16 v[124:127], v[188:191], a[124:127], v[124:127]
    s_waitcnt vmcnt(8)
    v_mfma_f32_16x16x32_bf16 v[64:67], v[192:195], v[128:131], v[64:67]
    v_mfma_f32_16x16x32_bf16 v[68:71], v[196:199], v[128:131], v[68:71]
    v_mfma_f32_16x16x32_bf16 v[72:75], v[200:203], v[128:131], v[72:75]
    v_mfma_f32_16x16x32_bf16 v[76:79], v[204:207], v[128:131], v[76:79]
    v_mfma_f32_16x16x32_bf16 v[80:83], v[192:195], v[132:135], v[80:83]
    v_mfma_f32_16x16x32_bf16 v[84:87], v[196:199], v[132:135], v[84:87]
    v_mfma_f32_16x16x32_bf16 v[88:91], v[200:203], v[132:135], v[88:91]
    v_mfma_f32_16x16x32_bf16 v[92:95], v[204:207], v[132:135], v[92:95]
    v_mfma_f32_16x16x32_bf16 v[96:99], v[192:195], v[136:139], v[96:99]
    v_mfma_f32_16x16x32_bf16 v[100:103], v[196:199], v[136:139], v[100:103]
    v_mfma_f32_16x16x32_bf16 v[104:107], v[200:203], v[136:139], v[104:107]
    v_mfma_f32_16x16x32_bf16 v[108:111], v[204:207], v[136:139], v[108:111]
    v_mfma_f32_16x16x32_bf16 v[112:115], v[192:195], v[140:143], v[112:115]
    v_mfma_f32_16x16x32_bf16 v[116:119], v[196:199], v[140:143], v[116:119]
    v_mfma_f32_16x16x32_bf16 v[120:123], v[200:203], v[140:143], v[120:123]
    v_mfma_f32_16x16x32_bf16 v[124:127], v[204:207], v[140:143], v[124:127]
    s_waitcnt vmcnt(4)
    v_mfma_f32_16x16x32_bf16 v[64:67], v[208:211], v[144:147], v[64:67]
    v_mfma_f32_16x16x32_bf16 v[68:71], v[212:215], v[144:147], v[68:71]
    v_mfma_f32_16x16x32_bf16 v[72:75], v[216:219], v[144:147], v[72:75]
    v_mfma_f32_16x16x32_bf16 v[76:79], v[220:223], v[144:147], v[76:79]
    v_mfma_f32_16x16x32_bf16 v[80:83], v[208:211], v[148:151], v[80:83]
    v_mfma_f32_16x16x32_bf16 v[84:87], v[212:215], v[148:151], v[84:87]
    v_mfma_f32_16x16x32_bf16 v[88:91], v[216:219], v[148:151], v[88:91]
    v_mfma_f32_16x16x32_bf16 v[92:95], v[220:223], v[148:151], v[92:95]
    v_mfma_f32_16x16x32_bf16 v[96:99], v[208:211], v[152:155], v[96:99]
    v_mfma_f32_16x16x32_bf16 v[100:103], v[212:215], v[152:155], v[100:103]
    v_mfma_f32_16x16x32_bf16 v[104:107], v[216:219], v[152:155], v[104:107]
    v_mfma_f32_16x16x32_bf16 v[108:111], v[220:223], v[152:155], v[108:111]
    v_mfma_f32_16x16x32_bf16 v[112:115], v[208:211], v[156:159], v[112:115]
    v_mfma_f32_16x16x32_bf16 v[116:119], v[212:215], v[156:159], v[116:119]
    v_mfma_f32_16x16x32_bf16 v[120:123], v[216:219], v[156:159], v[120:123]
    v_mfma_f32_16x16x32_bf16 v[124:127], v[220:223], v[156:159], v[124:127]
    s_waitcnt vmcnt(0)
    v_mfma_f32_16x16x32_bf16 v[64:67], v[224:227], v[160:163], v[64:67]
    v_mfma_f32_16x16x32_bf16 v[68:71], v[228:231], v[160:163], v[68:71]
    v_mfma_f32_16x16x32_bf16 v[72:75], v[232:235], v[160:163], v[72:75]
    v_mfma_f32_16x16x32_bf16 v[76:79], v[236:239], v[160:163], v[76:79]
    v_mfma_f32_16x16x32_bf16 v[80:83], v[224:227], v[164:167], v[80:83]
    v_mfma_f32_16x16x32_bf16 v[84:87], v[228:231], v[164:167], v[84:87]
    v_mfma_f32_16x16x32_bf16 v[88:91], v[232:235], v[164:167], v[88:91]
    v_mfma_f32_16x16x32_bf16 v[92:95], v[236:239], v[164:167], v[92:95]
    v_mfma_f32_16x16x32_bf16 v[96:99], v[224:227], v[168:171], v[96:99]
    v_mfma_f32_16x16x32_bf16 v[100:103], v[228:231], v[168:171], v[100:103]
    v_mfma_f32_16x16x32_bf16 v[104:107], v[232:235], v[168:171], v[104:107]
    v_mfma_f32_16x16x32_bf16 v[108:111], v[236:239], v[168:171], v[108:111]
    v_mfma_f32_16x16x32_bf16 v[112:115], v[224:227], v[172:175], v[112:115]
    v_mfma_f32_16x16x32_bf16 v[116:119], v[228:231], v[172:175], v[116:119]
    v_mfma_f32_16x16x32_bf16 v[120:123], v[232:235], v[172:175], v[120:123]
    v_mfma_f32_16x16x32_bf16 v[124:127], v[236:239], v[172:175], v[124:127]
    s_add_u32 s7, s3, 1
    s_and_b32 s7, s7, 3
    s_lshl_b32 s7, s7, 12
    s_add_u32 s7, s7, 0
    v_add_u32 v27, s7, v4
    s_add_u32 s7, s3, 2
    s_and_b32 s7, s7, 3
    s_lshl_b32 s7, s7, 12
    s_add_u32 s7, s7, 16384
    v_add_u32 v28, s7, v4
    s_add_u32 s7, s3, 3
    s_and_b32 s7, s7, 3
    s_lshl_b32 s7, s7, 12
    s_add_u32 s7, s7, 32768
    v_add_u32 v29, s7, v4
    v_lshlrev_b32 v22, 5, v3
    v_add_u32 v22, 161536, v22
    ds_read_b128 v[168:171], v22 offset:256
    ds_read_b128 v[172:175], v22 offset:272
    ds_read_b128 v[176:179], v22 offset:384
    ds_read_b128 v[180:183], v22 offset:400
    s_barrier
    ds_write_b128 v27, v[80:83] offset:0
    ds_write_b128 v27, v[84:87] offset:1024
    ds_write_b128 v27, v[88:91] offset:2048
    ds_write_b128 v27, v[92:95] offset:3072
    ds_write_b128 v28, v[96:99] offset:0
    ds_write_b128 v28, v[100:103] offset:1024
    ds_write_b128 v28, v[104:107] offset:2048
    ds_write_b128 v28, v[108:111] offset:3072
    ds_write_b128 v29, v[112:115] offset:0
    ds_write_b128 v29, v[116:119] offset:1024
    ds_write_b128 v29, v[120:123] offset:2048
    ds_write_b128 v29, v[124:127] offset:3072
    v_accvgpr_read_b32 v160, a240
    v_accvgpr_read_b32 v161, a241
    v_accvgpr_read_b32 v162, a242
    v_accvgpr_read_b32 v163, a243
    v_accvgpr_read_b32 v164, a244
    v_accvgpr_read_b32 v165, a245
    v_accvgpr_read_b32 v166, a246
    v_accvgpr_read_b32 v167, a247
    v_lshlrev_b32 v192, 16, v160
    v_and_b32 v193, 0xffff0000, v160
    v_lshlrev_b32 v194, 16, v161
    v_and_b32 v195, 0xffff0000, v161
    v_lshlrev_b32 v196, 16, v162
    v_and_b32 v197, 0xffff0000, v162
    v_lshlrev_b32 v198, 16, v163
    v_and_b32 v199, 0xffff0000, v163
    v_lshlrev_b32 v200, 16, v164
    v_and_b32 v201, 0xffff0000, v164
    v_lshlrev_b32 v202, 16, v165
    v_and_b32 v203, 0xffff0000, v165
    v_lshlrev_b32 v204, 16, v166
    v_and_b32 v205, 0xffff0000, v166
    v_lshlrev_b32 v206, 16, v167
    v_and_b32 v207, 0xffff0000, v167
    v_add_u32 v26, 0, v16
    s_waitcnt lgkmcnt(0)
    s_barrier
    ds_read_b128 v[80:83], v26 offset:0
    ds_read_b128 v[84:87], v26 offset:1024
    ds_read_b128 v[88:91], v26 offset:2048
    ds_read_b128 v[92:95], v26 offset:3072
    ds_read_b128 v[96:99], v26 offset:16384
    ds_read_b128 v[100:103], v26 offset:17408
    ds_read_b128 v[104:107], v26 offset:18432
    ds_read_b128 v[108:111], v26 offset:19456
    ds_read_b128 v[112:115], v26 offset:32768
    ds_read_b128 v[116:119], v26 offset:33792
    ds_read_b128 v[120:123], v26 offset:34816
    ds_read_b128 v[124:127], v26 offset:35840
    s_waitcnt lgkmcnt(8)
    v_add_f32 v64, v64, v80
    v_add_f32 v65, v65, v81
    v_add_f32 v66, v66, v82
    v_add_f32 v67, v67, v83
    v_add_f32 v68, v68, v84
    v_add_f32 v69, v69, v85
    v_add_f32 v70, v70, v86
    v_add_f32 v71, v71, v87
    v_add_f32 v72, v72, v88
    v_add_f32 v73, v73, v89
    v_add_f32 v74, v74, v90
    v_add_f32 v75, v75, v91
    v_add_f32 v76, v76, v92
    v_add_f32 v77, v77, v93
    v_add_f32 v78, v78, v94
    v_add_f32 v79, v79, v95
    s_waitcnt lgkmcnt(0)
    v_add_f32 v96, v96, v112
    v_add_f32 v97, v97, v113
    v_add_f32 v98, v98, v114
    v_add_f32 v99, v99, v115
    v_add_f32 v100, v100, v116
    v_add_f32 v101, v101, v117
    v_add_f32 v102, v102, v118
    v_add_f32 v103, v103, v119
    v_add_f32 v104, v104, v120
    v_add_f32 v105, v105, v121
    v_add_f32 v106, v106, v122
    v_add_f32 v107, v107, v123
    v_add_f32 v108, v108, v124
    v_add_f32 v109, v109, v125
    v_add_f32 v110, v110, v126
    v_add_f32 v111, v111, v127
    v_add_f32 v64, v64, v96
    v_add_f32 v65, v65, v97
    v_add_f32 v66, v66, v98
    v_add_f32 v67, v67, v99
    v_add_f32 v68, v68, v100
    v_add_f32 v69, v69, v101
    v_add_f32 v70, v70, v102
    v_add_f32 v71, v71, v103
    v_add_f32 v72, v72, v104
    v_add_f32 v73, v73, v105
    v_add_f32 v74, v74, v106
    v_add_f32 v75, v75, v107
    v_add_f32 v76, v76, v108
    v_add_f32 v77, v77, v109
    v_add_f32 v78, v78, v110
    v_add_f32 v79, v79, v111
    v_fma_f32 v64, v64, v168, v192
    v_fma_f32 v65, v65, v169, v193
    v_fma_f32 v66, v66, v170, v194
    v_fma_f32 v67, v67, v171, v195
    v_fma_f32 v68, v68, v172, v196
    v_fma_f32 v69, v69, v173, v197
    v_fma_f32 v70, v70, v174, v198
    v_fma_f32 v71, v71, v175, v199
    v_fma_f32 v72, v72, v176, v200
    v_fma_f32 v73, v73, v177, v201
    v_fma_f32 v74, v74, v178, v202
    v_fma_f32 v75, v75, v179, v203
    v_fma_f32 v76, v76, v180, v204
    v_fma_f32 v77, v77, v181, v205
    v_fma_f32 v78, v78, v182, v206
    v_fma_f32 v79, v79, v183, v207
    v_cvt_pk_bf16_f32 v184, v64, v65
    v_cvt_pk_bf16_f32 v185, v66, v67
    v_cvt_pk_bf16_f32 v186, v68, v69
    v_cvt_pk_bf16_f32 v187, v70, v71
    v_cvt_pk_bf16_f32 v188, v72, v73
    v_cvt_pk_bf16_f32 v189, v74, v75
    v_cvt_pk_bf16_f32 v190, v76, v77
    v_cvt_pk_bf16_f32 v191, v78, v79
    s_lshl_b32 s35, s67, 1
    buffer_store_dwordx4 v[184:187], v25, s[40:43], s35 offen
    buffer_store_dwordx4 v[188:191], v25, s[40:43], s35 offen offset:64
    s_waitcnt vmcnt(0)
    s_endpgm
L_codeend:
.section .rodata,"a"
.p2align 6
.amdhsa_kernel k0_kernel
  .amdhsa_next_free_vgpr 128
  .amdhsa_next_free_sgpr 102
  .amdhsa_accum_offset 128
  .amdhsa_group_segment_fixed_size 0
  .amdhsa_kernarg_size 96
  .amdhsa_user_sgpr_count 2
  .amdhsa_user_sgpr_kernarg_segment_ptr 1
  .amdhsa_system_sgpr_workgroup_id_x 1
.end_amdhsa_kernel
.section .rodata,"a"
.p2align 6
.amdhsa_kernel k1_kernel
  .amdhsa_next_free_vgpr 512
  .amdhsa_next_free_sgpr 102
  .amdhsa_accum_offset 256
  .amdhsa_group_segment_fixed_size 0
  .amdhsa_kernarg_size 96
  .amdhsa_user_sgpr_count 2
  .amdhsa_user_sgpr_kernarg_segment_ptr 1
  .amdhsa_system_sgpr_workgroup_id_x 1
.end_amdhsa_kernel
```
